```python
import torch

def _softmax(x, axis=-1):
    return torch.softmax(x, dim=axis)

def _gelu(x):
    return torch.nn.functional.gelu(x, approximate='tanh')

def _silu(x):
    return torch.nn.functional.silu(x)

def _sigmoid(x):
    return torch.sigmoid(x)

def _layernorm(x, axis=-1, eps=1e-05):
    m = x.mean(dim=axis, keepdim=True)
    v = x.var(dim=axis, keepdim=True, unbiased=False)
    return (x - m) / torch.sqrt(v + eps)

def _scatter_add(tgt, idx, src, axis=0):
    return tgt.clone().index_add_(axis, idx, src)

def _segment_sum(src, seg, n):
    out = torch.zeros((n,) + src.shape[1:], dtype=src.dtype)
    return out.index_add_(0, seg, src)

def _pad(x, pw):
    flat = tuple((v for pair in reversed(pw) for v in pair))
    return torch.nn.functional.pad(x, flat)
kernel_name = 'standalone__tree_speculative_verify_tree_attention_over_candidate_token_tree__decode'

def setup_inputs():

    _w = lambda a: (lambda t: t.to(torch.bfloat16) if t.is_floating_point() else t)(torch.as_tensor(a))
    B, Hq, Hkv, T, C, D = (2, 32, 16, 1, 32768, 128)
    tree_mask = torch.zeros((B, T, T), dtype=float)
    for b in range(B):
        parent = torch.zeros(T, dtype=torch.int64)
        for i in range(1, T):
            parent[i] = int(torch.randint(0, i, (1,)).item())
        for i in range(T):
            j = i
            tree_mask[b, i, j] = 1.0
            while j > 0:
                j = parent[j]
                tree_mask[b, i, j] = 1.0
    return {'q': _w((lambda *s: torch.randn(*s, dtype=torch.bfloat16) * 0.8)(B, Hq, T, D)), 'k_cache': _w((lambda *s: torch.randn(*s, dtype=torch.bfloat16) * 0.8)(B, Hkv, C, D)), 'v_cache': _w((lambda *s: torch.randn(*s, dtype=torch.bfloat16) * 0.05)(B, Hkv, C, D)), 'k_tree': _w((lambda *s: torch.randn(*s, dtype=torch.bfloat16) * 0.8)(B, Hkv, T, D)), 'v_tree': _w((lambda *s: torch.randn(*s, dtype=torch.bfloat16) * 0.05)(B, Hkv, T, D)), 'tree_mask': _w(tree_mask)}

def reference(q, k_cache, v_cache, k_tree, v_tree, tree_mask):
    B, Hq, T, D = q.shape
    Hkv, C = (k_cache.shape[1], k_cache.shape[2])
    rep = Hq // Hkv
    kc = (lambda x, n, axis: torch.repeat_interleave(x, n, dim=axis))(k_cache, rep, axis=1)
    vc = (lambda x, n, axis: torch.repeat_interleave(x, n, dim=axis))(v_cache, rep, axis=1)
    kt = (lambda x, n, axis: torch.repeat_interleave(x, n, dim=axis))(k_tree, rep, axis=1)
    vt = (lambda x, n, axis: torch.repeat_interleave(x, n, dim=axis))(v_tree, rep, axis=1)
    k = torch.concatenate([kc, kt], axis=2)
    v = torch.concatenate([vc, vt], axis=2)
    scale = D ** (-0.5)
    scores = torch.einsum('bhqd,bhkd->bhqk', q, k) * scale
    ctx_mask = torch.ones((B, 1, T, C), dtype=scores.dtype)
    tm = tree_mask[:, None, :, :].clone()
    full_mask = torch.concatenate([ctx_mask, tm], axis=-1)
    scores = scores + (1.0 - full_mask) * -1000000000.0
    p = _softmax(scores, axis=-1)
    return torch.einsum('bhqk,bhkd->bhqd', p, v)
```

```asm
; @launch grid=(256,1,1) block=(128,1,1) lds=34368
.amdgcn_target "amdgcn-amd-amdhsa--gfx950"
.text
.globl standalone__tree_speculative_verify_tree_attention_over_candidate_token_tree__decode_kernel
.p2align 8
.type standalone__tree_speculative_verify_tree_attention_over_candidate_token_tree__decode_kernel,@function
standalone__tree_speculative_verify_tree_attention_over_candidate_token_tree__decode_kernel:
    s_load_dwordx16 s[4:19], s[0:1], 0
    s_cmp_ge_u32 s2, 256
    s_cbranch_scc1 L_end
    v_readfirstlane_b32 s49, v0
    v_and_b32 v0, 63, v0
    s_and_b32 s41, s2, 7
    s_lshr_b32 s40, s2, 3
    v_bfe_u32 v2, v0, 2, 2
    v_lshrrev_b32 v3, 4, v0
    v_and_b32 v166, 3, v0
    v_lshlrev_b32 v166, 4, v166
    v_lshl_add_u32 v166, v3, 6, v166
    v_lshl_add_u32 v169, v2, 8, v166
    v_bfe_u32 v2, v0, 3, 1
    v_lshl_add_u32 v167, v2, 8, v166
    v_lshlrev_b32 v170, 4, v0
    v_lshlrev_b32 v171, 2, v0
    v_mov_b32 v176, 0
    s_lshl_b32 s23, s40, 9
    s_mov_b32 s30, 512
    s_mov_b32 s31, 0x20000
    s_cmp_lg_u32 s49, 0
    s_cbranch_scc1 L_helper
    v_and_b32 v2, 4, v0
    v_lshl_add_u32 v3, v2, 8, v167
    v_xor_b32 v2, 0x400, v3
    s_lshl_b32 s22, s40, 23
    s_bitcmp1_b32 s2, 0
    s_cselect_b32 s47, 0x202000, 0
    s_bitcmp1_b32 s2, 1
    s_cselect_b32 s34, 0x14000, 0
    s_xor_b32 s47, s47, s34
    s_bitcmp1_b32 s2, 2
    s_cselect_b32 s34, 0x40000, 0
    s_xor_b32 s47, s47, s34
    s_bitcmp1_b32 s2, 3
    s_cselect_b32 s34, 0x4000, 0
    s_xor_b32 s47, s47, s34
    s_bitcmp1_b32 s2, 4
    s_cselect_b32 s34, 0x100000, 0
    s_xor_b32 s47, s47, s34
    s_bitcmp1_b32 s2, 5
    s_cselect_b32 s34, 0x42000, 0
    s_xor_b32 s47, s47, s34
    s_mov_b32 s36, 0x21242004
    s_mov_b32 s37, 0x1a4308
    s_mov_b32 s34, 0
    s_mov_b32 s33, s47
    s_mov_b32 s32, s47
    s_mov_b32 s26, 8388608
    s_mov_b32 s27, 0x20000
    s_waitcnt lgkmcnt(0)
    s_add_u32 s28, s4, s23
    s_addc_u32 s29, s5, 0
    s_add_u32 s24, s6, s22
    s_addc_u32 s25, s7, 0
    buffer_load_dwordx4 v[148:151], v3, s[28:31], 0 offen
    buffer_load_dwordx4 v[152:155], v2, s[28:31], 0 offen
    buffer_load_dwordx4 v[4:7], v169, s[24:27], s32 offen offset:0 nt
    buffer_load_dwordx4 v[8:11], v169, s[24:27], s32 offen offset:1024 nt
    buffer_load_dwordx4 v[12:15], v169, s[24:27], s32 offen offset:2048 nt
    buffer_load_dwordx4 v[16:19], v169, s[24:27], s32 offen offset:3072 nt
    s_xor_b32 s32, s33, 0x8000
    buffer_load_dwordx4 v[20:23], v169, s[24:27], s32 offen offset:0 nt
    buffer_load_dwordx4 v[24:27], v169, s[24:27], s32 offen offset:1024 nt
    buffer_load_dwordx4 v[28:31], v169, s[24:27], s32 offen offset:2048 nt
    buffer_load_dwordx4 v[32:35], v169, s[24:27], s32 offen offset:3072 nt
    s_xor_b32 s32, s33, 0x1000
    buffer_load_dwordx4 v[36:39], v169, s[24:27], s32 offen offset:0 nt
    buffer_load_dwordx4 v[40:43], v169, s[24:27], s32 offen offset:1024 nt
    buffer_load_dwordx4 v[44:47], v169, s[24:27], s32 offen offset:2048 nt
    buffer_load_dwordx4 v[48:51], v169, s[24:27], s32 offen offset:3072 nt
    s_xor_b32 s32, s33, 0x9000
    buffer_load_dwordx4 v[52:55], v169, s[24:27], s32 offen offset:0 nt
    buffer_load_dwordx4 v[56:59], v169, s[24:27], s32 offen offset:1024 nt
    buffer_load_dwordx4 v[60:63], v169, s[24:27], s32 offen offset:2048 nt
    buffer_load_dwordx4 v[64:67], v169, s[24:27], s32 offen offset:3072 nt
    s_xor_b32 s32, s33, 0x6000
    buffer_load_dwordx4 v[68:71], v169, s[24:27], s32 offen offset:0 nt
    buffer_load_dwordx4 v[72:75], v169, s[24:27], s32 offen offset:1024 nt
    buffer_load_dwordx4 v[76:79], v169, s[24:27], s32 offen offset:2048 nt
    buffer_load_dwordx4 v[80:83], v169, s[24:27], s32 offen offset:3072 nt
    s_xor_b32 s32, s33, 0xe000
    buffer_load_dwordx4 v[84:87], v169, s[24:27], s32 offen offset:0 nt
    buffer_load_dwordx4 v[88:91], v169, s[24:27], s32 offen offset:1024 nt
    buffer_load_dwordx4 v[92:95], v169, s[24:27], s32 offen offset:2048 nt
    s_load_dwordx2 s[20:21], s[0:1], 64
    s_add_u32 s44, s8, s22
    s_addc_u32 s45, s9, 0
    v_and_b32 v1, 1, v0
    v_lshlrev_b32 v1, 4, v1
    v_mov_b32 v2, 0xffff
    v_lshlrev_b32 v1, v1, v2
    v_bfe_u32 v2, v0, 1, 2
    v_cmp_eq_u32 vcc, 0, v2
    s_nop 1
    v_cndmask_b32 v156, 0, v1, vcc
    v_cmp_eq_u32 vcc, 1, v2
    s_nop 1
    v_cndmask_b32 v157, 0, v1, vcc
    v_cmp_eq_u32 vcc, 2, v2
    s_nop 1
    v_cndmask_b32 v158, 0, v1, vcc
    v_cmp_eq_u32 vcc, 3, v2
    s_nop 1
    v_cndmask_b32 v159, 0, v1, vcc
    v_mov_b32 v165, 0x3e0293ee
    s_mov_b32 s50, 0x22222222
    s_mov_b32 s51, 0x22222222
    s_mov_b32 s52, 0x44444444
    s_mov_b32 s53, 0x44444444
    s_mov_b32 s54, 0x88888888
    s_mov_b32 s55, 0x88888888
    v_mov_b32 v164, 0xff800000
    v_mov_b32 v168, v164
    v_mov_b32 v140, v164
    v_mov_b32 v141, v164
    v_mov_b32 v142, v164
    v_mov_b32 v143, v164
    v_mov_b32 v144, v164
    v_mov_b32 v145, v164
    v_mov_b32 v146, v164
    v_mov_b32 v147, v164
    v_mov_b32 v160, 0
    v_mov_b32 v161, 0
    v_mov_b32 v162, 0
    v_mov_b32 v163, 0
    s_mov_b32 s61, 0
    s_mov_b32 s60, 1
    s_mov_b32 s56, 0x10201004
    s_mov_b32 s57, 0x00804022
    s_waitcnt lgkmcnt(0)
    s_mul_i32 s22, s40, 8192
    s_add_u32 s28, s20, s22
    s_addc_u32 s29, s21, 0
    s_mov_b32 s30, 8192
    s_mul_i32 s41, s41, 1024
    s_barrier
L_p1_1:
    s_waitcnt vmcnt(19)
    buffer_load_dwordx4 v[96:99], v169, s[24:27], s32 offen offset:3072 nt
    v_mfma_f32_16x16x32_bf16 v[132:135], v[4:7], v[148:151], 0
    s_xor_b32 s32, s33, 0x7000
    v_mul_f32_dpp v166, v140, v165 quad_perm:[0,0,0,0] row_mask:0xf bank_mask:0xf
    v_mul_f32_dpp v167, v144, v165 quad_perm:[0,0,0,0] row_mask:0xf bank_mask:0xf
    s_waitcnt vmcnt(19)
    buffer_load_dwordx4 v[100:103], v169, s[24:27], s32 offen offset:0 nt
    v_mfma_f32_16x16x32_bf16 v[132:135], v[8:11], v[152:155], v[132:135]
    v_fmac_f32_dpp v166, v141, v165 quad_perm:[1,1,1,1] row_mask:0xf bank_mask:0xf
    v_fmac_f32_dpp v167, v145, v165 quad_perm:[1,1,1,1] row_mask:0xf bank_mask:0xf
    s_add_u32 s61, s61, 1
    s_bitcmp1_b64 s[56:57], s61
    s_cbranch_scc1 L_p1_1_ev
L_p1_1_ev_back:
    s_waitcnt vmcnt(19)
    buffer_load_dwordx4 v[104:107], v169, s[24:27], s32 offen offset:1024 nt
    v_mfma_f32_16x16x32_bf16 v[136:139], v[12:15], v[148:151], 0
    v_fmac_f32_dpp v166, v142, v165 quad_perm:[2,2,2,2] row_mask:0xf bank_mask:0xf
    v_fmac_f32_dpp v167, v146, v165 quad_perm:[2,2,2,2] row_mask:0xf bank_mask:0xf
    s_waitcnt vmcnt(19)
    buffer_load_dwordx4 v[108:111], v169, s[24:27], s32 offen offset:2048 nt
    v_mfma_f32_16x16x32_bf16 v[136:139], v[16:19], v[152:155], v[136:139]
    v_fmac_f32_dpp v166, v143, v165 quad_perm:[3,3,3,3] row_mask:0xf bank_mask:0xf
    v_fmac_f32_dpp v167, v147, v165 quad_perm:[3,3,3,3] row_mask:0xf bank_mask:0xf
    v_cndmask_b32 v168, v168, v166, s[52:53]
    v_cndmask_b32 v168, v168, v167, s[54:55]
    ds_write_b32 v171, v168 offset:0
    v_max_f32 v164, v164, v168
    s_waitcnt vmcnt(19)
    buffer_load_dwordx4 v[112:115], v169, s[24:27], s32 offen offset:3072 nt
    v_mfma_f32_16x16x32_bf16 v[140:143], v[20:23], v[148:151], 0
    s_xor_b32 s32, s33, 0xf000
    s_add_u32 s34, s34, 1
    s_or_b32 s38, s34, 16
    v_mul_f32_dpp v168, v132, v165 quad_perm:[0,0,0,0] row_mask:0xf bank_mask:0xf
    v_mul_f32_dpp v167, v136, v165 quad_perm:[0,0,0,0] row_mask:0xf bank_mask:0xf
    s_waitcnt vmcnt(19)
    buffer_load_dwordx4 v[116:119], v169, s[24:27], s32 offen offset:0 nt
    v_mfma_f32_16x16x32_bf16 v[140:143], v[24:27], v[152:155], v[140:143]
    s_ff1_i32_b32 s38, s38
    s_mul_i32 s38, s38, 11
    v_fmac_f32_dpp v168, v133, v165 quad_perm:[1,1,1,1] row_mask:0xf bank_mask:0xf
    v_fmac_f32_dpp v167, v137, v165 quad_perm:[1,1,1,1] row_mask:0xf bank_mask:0xf
    s_waitcnt vmcnt(19)
    buffer_load_dwordx4 v[120:123], v169, s[24:27], s32 offen offset:1024 nt
    v_mfma_f32_16x16x32_bf16 v[144:147], v[28:31], v[148:151], 0
    s_lshr_b64 s[38:39], s[36:37], s38
    s_and_b32 s38, s38, 0x7ff
    v_fmac_f32_dpp v168, v134, v165 quad_perm:[2,2,2,2] row_mask:0xf bank_mask:0xf
    v_fmac_f32_dpp v167, v138, v165 quad_perm:[2,2,2,2] row_mask:0xf bank_mask:0xf
    s_waitcnt vmcnt(19)
    buffer_load_dwordx4 v[124:127], v169, s[24:27], s32 offen offset:2048 nt
    v_mfma_f32_16x16x32_bf16 v[144:147], v[32:35], v[152:155], v[144:147]
    s_lshl_b32 s38, s38, 12
    s_xor_b32 s33, s33, s38
    v_fmac_f32_dpp v168, v135, v165 quad_perm:[3,3,3,3] row_mask:0xf bank_mask:0xf
    v_fmac_f32_dpp v167, v139, v165 quad_perm:[3,3,3,3] row_mask:0xf bank_mask:0xf
    v_cndmask_b32 v168, v168, v167, s[50:51]
    s_waitcnt vmcnt(19)
    buffer_load_dwordx4 v[128:131], v169, s[24:27], s32 offen offset:3072 nt
    v_mfma_f32_16x16x32_bf16 v[132:135], v[36:39], v[148:151], 0
    s_mov_b32 s32, s33
    s_cmp_eq_u32 s61, 32
    s_cbranch_scc1 L_p1_1_toV
L_p1_1_toV_back:
    v_mul_f32_dpp v166, v140, v165 quad_perm:[0,0,0,0] row_mask:0xf bank_mask:0xf
    v_mul_f32_dpp v167, v144, v165 quad_perm:[0,0,0,0] row_mask:0xf bank_mask:0xf
    s_waitcnt vmcnt(19)
    buffer_load_dwordx4 v[4:7], v169, s[24:27], s32 offen offset:0 nt
    v_mfma_f32_16x16x32_bf16 v[132:135], v[40:43], v[152:155], v[132:135]
    v_fmac_f32_dpp v166, v141, v165 quad_perm:[1,1,1,1] row_mask:0xf bank_mask:0xf
    v_fmac_f32_dpp v167, v145, v165 quad_perm:[1,1,1,1] row_mask:0xf bank_mask:0xf
    s_waitcnt vmcnt(19)
    buffer_load_dwordx4 v[8:11], v169, s[24:27], s32 offen offset:1024 nt
    v_mfma_f32_16x16x32_bf16 v[136:139], v[44:47], v[148:151], 0
    v_fmac_f32_dpp v166, v142, v165 quad_perm:[2,2,2,2] row_mask:0xf bank_mask:0xf
    v_fmac_f32_dpp v167, v146, v165 quad_perm:[2,2,2,2] row_mask:0xf bank_mask:0xf
    s_waitcnt vmcnt(19)
    buffer_load_dwordx4 v[12:15], v169, s[24:27], s32 offen offset:2048 nt
    v_mfma_f32_16x16x32_bf16 v[136:139], v[48:51], v[152:155], v[136:139]
    v_fmac_f32_dpp v166, v143, v165 quad_perm:[3,3,3,3] row_mask:0xf bank_mask:0xf
    v_fmac_f32_dpp v167, v147, v165 quad_perm:[3,3,3,3] row_mask:0xf bank_mask:0xf
    v_cndmask_b32 v168, v168, v166, s[52:53]
    v_cndmask_b32 v168, v168, v167, s[54:55]
    ds_write_b32 v171, v168 offset:256
    v_max_f32 v164, v164, v168
    s_waitcnt vmcnt(19)
    buffer_load_dwordx4 v[16:19], v169, s[24:27], s32 offen offset:3072 nt
    v_mfma_f32_16x16x32_bf16 v[140:143], v[52:55], v[148:151], 0
    s_xor_b32 s32, s33, 0x8000
    v_mul_f32_dpp v168, v132, v165 quad_perm:[0,0,0,0] row_mask:0xf bank_mask:0xf
    v_mul_f32_dpp v167, v136, v165 quad_perm:[0,0,0,0] row_mask:0xf bank_mask:0xf
    s_waitcnt vmcnt(19)
    buffer_load_dwordx4 v[20:23], v169, s[24:27], s32 offen offset:0 nt
    v_mfma_f32_16x16x32_bf16 v[140:143], v[56:59], v[152:155], v[140:143]
    v_fmac_f32_dpp v168, v133, v165 quad_perm:[1,1,1,1] row_mask:0xf bank_mask:0xf
    v_fmac_f32_dpp v167, v137, v165 quad_perm:[1,1,1,1] row_mask:0xf bank_mask:0xf
    s_waitcnt vmcnt(19)
    buffer_load_dwordx4 v[24:27], v169, s[24:27], s32 offen offset:1024 nt
    v_mfma_f32_16x16x32_bf16 v[144:147], v[60:63], v[148:151], 0
    v_fmac_f32_dpp v168, v134, v165 quad_perm:[2,2,2,2] row_mask:0xf bank_mask:0xf
    v_fmac_f32_dpp v167, v138, v165 quad_perm:[2,2,2,2] row_mask:0xf bank_mask:0xf
    s_waitcnt vmcnt(19)
    buffer_load_dwordx4 v[28:31], v169, s[24:27], s32 offen offset:2048 nt
    v_mfma_f32_16x16x32_bf16 v[144:147], v[64:67], v[152:155], v[144:147]
    v_fmac_f32_dpp v168, v135, v165 quad_perm:[3,3,3,3] row_mask:0xf bank_mask:0xf
    v_fmac_f32_dpp v167, v139, v165 quad_perm:[3,3,3,3] row_mask:0xf bank_mask:0xf
    v_cndmask_b32 v168, v168, v167, s[50:51]
    s_waitcnt vmcnt(19)
    buffer_load_dwordx4 v[32:35], v169, s[24:27], s32 offen offset:3072 nt
    v_mfma_f32_16x16x32_bf16 v[132:135], v[68:71], v[148:151], 0
    s_xor_b32 s32, s33, 0x1000
    v_mul_f32_dpp v166, v140, v165 quad_perm:[0,0,0,0] row_mask:0xf bank_mask:0xf
    v_mul_f32_dpp v167, v144, v165 quad_perm:[0,0,0,0] row_mask:0xf bank_mask:0xf
    s_waitcnt vmcnt(19)
    buffer_load_dwordx4 v[36:39], v169, s[24:27], s32 offen offset:0 nt
    v_mfma_f32_16x16x32_bf16 v[132:135], v[72:75], v[152:155], v[132:135]
    v_fmac_f32_dpp v166, v141, v165 quad_perm:[1,1,1,1] row_mask:0xf bank_mask:0xf
    v_fmac_f32_dpp v167, v145, v165 quad_perm:[1,1,1,1] row_mask:0xf bank_mask:0xf
    s_waitcnt vmcnt(19)
    buffer_load_dwordx4 v[40:43], v169, s[24:27], s32 offen offset:1024 nt
    v_mfma_f32_16x16x32_bf16 v[136:139], v[76:79], v[148:151], 0
    v_fmac_f32_dpp v166, v142, v165 quad_perm:[2,2,2,2] row_mask:0xf bank_mask:0xf
    v_fmac_f32_dpp v167, v146, v165 quad_perm:[2,2,2,2] row_mask:0xf bank_mask:0xf
    s_waitcnt vmcnt(19)
    buffer_load_dwordx4 v[44:47], v169, s[24:27], s32 offen offset:2048 nt
    v_mfma_f32_16x16x32_bf16 v[136:139], v[80:83], v[152:155], v[136:139]
    v_fmac_f32_dpp v166, v143, v165 quad_perm:[3,3,3,3] row_mask:0xf bank_mask:0xf
    v_fmac_f32_dpp v167, v147, v165 quad_perm:[3,3,3,3] row_mask:0xf bank_mask:0xf
    v_cndmask_b32 v168, v168, v166, s[52:53]
    v_cndmask_b32 v168, v168, v167, s[54:55]
    ds_write_b32 v171, v168 offset:512
    v_max_f32 v164, v164, v168
    s_waitcnt vmcnt(19)
    buffer_load_dwordx4 v[48:51], v169, s[24:27], s32 offen offset:3072 nt
    v_mfma_f32_16x16x32_bf16 v[140:143], v[84:87], v[148:151], 0
    s_xor_b32 s32, s33, 0x9000
    v_mul_f32_dpp v168, v132, v165 quad_perm:[0,0,0,0] row_mask:0xf bank_mask:0xf
    v_mul_f32_dpp v167, v136, v165 quad_perm:[0,0,0,0] row_mask:0xf bank_mask:0xf
    s_waitcnt vmcnt(19)
    buffer_load_dwordx4 v[52:55], v169, s[24:27], s32 offen offset:0 nt
    v_mfma_f32_16x16x32_bf16 v[140:143], v[88:91], v[152:155], v[140:143]
    v_fmac_f32_dpp v168, v133, v165 quad_perm:[1,1,1,1] row_mask:0xf bank_mask:0xf
    v_fmac_f32_dpp v167, v137, v165 quad_perm:[1,1,1,1] row_mask:0xf bank_mask:0xf
    s_waitcnt vmcnt(19)
    buffer_load_dwordx4 v[56:59], v169, s[24:27], s32 offen offset:1024 nt
    v_mfma_f32_16x16x32_bf16 v[144:147], v[92:95], v[148:151], 0
    v_fmac_f32_dpp v168, v134, v165 quad_perm:[2,2,2,2] row_mask:0xf bank_mask:0xf
    v_fmac_f32_dpp v167, v138, v165 quad_perm:[2,2,2,2] row_mask:0xf bank_mask:0xf
    s_waitcnt vmcnt(19)
    buffer_load_dwordx4 v[60:63], v169, s[24:27], s32 offen offset:2048 nt
    v_mfma_f32_16x16x32_bf16 v[144:147], v[96:99], v[152:155], v[144:147]
    v_fmac_f32_dpp v168, v135, v165 quad_perm:[3,3,3,3] row_mask:0xf bank_mask:0xf
    v_fmac_f32_dpp v167, v139, v165 quad_perm:[3,3,3,3] row_mask:0xf bank_mask:0xf
    v_cndmask_b32 v168, v168, v167, s[50:51]
    s_waitcnt vmcnt(19)
    buffer_load_dwordx4 v[64:67], v169, s[24:27], s32 offen offset:3072 nt
    v_mfma_f32_16x16x32_bf16 v[132:135], v[100:103], v[148:151], 0
    s_xor_b32 s32, s33, 0x6000
    v_mul_f32_dpp v166, v140, v165 quad_perm:[0,0,0,0] row_mask:0xf bank_mask:0xf
    v_mul_f32_dpp v167, v144, v165 quad_perm:[0,0,0,0] row_mask:0xf bank_mask:0xf
    s_waitcnt vmcnt(19)
    buffer_load_dwordx4 v[68:71], v169, s[24:27], s32 offen offset:0 nt
    v_mfma_f32_16x16x32_bf16 v[132:135], v[104:107], v[152:155], v[132:135]
    v_fmac_f32_dpp v166, v141, v165 quad_perm:[1,1,1,1] row_mask:0xf bank_mask:0xf
    v_fmac_f32_dpp v167, v145, v165 quad_perm:[1,1,1,1] row_mask:0xf bank_mask:0xf
    s_waitcnt vmcnt(19)
    buffer_load_dwordx4 v[72:75], v169, s[24:27], s32 offen offset:1024 nt
    v_mfma_f32_16x16x32_bf16 v[136:139], v[108:111], v[148:151], 0
    v_fmac_f32_dpp v166, v142, v165 quad_perm:[2,2,2,2] row_mask:0xf bank_mask:0xf
    v_fmac_f32_dpp v167, v146, v165 quad_perm:[2,2,2,2] row_mask:0xf bank_mask:0xf
    s_waitcnt vmcnt(19)
    buffer_load_dwordx4 v[76:79], v169, s[24:27], s32 offen offset:2048 nt
    v_mfma_f32_16x16x32_bf16 v[136:139], v[112:115], v[152:155], v[136:139]
    v_fmac_f32_dpp v166, v143, v165 quad_perm:[3,3,3,3] row_mask:0xf bank_mask:0xf
    v_fmac_f32_dpp v167, v147, v165 quad_perm:[3,3,3,3] row_mask:0xf bank_mask:0xf
    v_cndmask_b32 v168, v168, v166, s[52:53]
    v_cndmask_b32 v168, v168, v167, s[54:55]
    ds_write_b32 v171, v168 offset:768
    v_max_f32 v164, v164, v168
    ds_read_b32 v175, v176 offset:34304
    s_waitcnt vmcnt(19)
    buffer_load_dwordx4 v[80:83], v169, s[24:27], s32 offen offset:3072 nt
    v_mfma_f32_16x16x32_bf16 v[140:143], v[116:119], v[148:151], 0
    s_xor_b32 s32, s33, 0xe000
    v_mul_f32_dpp v168, v132, v165 quad_perm:[0,0,0,0] row_mask:0xf bank_mask:0xf
    v_mul_f32_dpp v167, v136, v165 quad_perm:[0,0,0,0] row_mask:0xf bank_mask:0xf
    v_add_u32 v171, 1024, v171
    s_waitcnt vmcnt(19)
    buffer_load_dwordx4 v[84:87], v169, s[24:27], s32 offen offset:0 nt
    v_mfma_f32_16x16x32_bf16 v[140:143], v[120:123], v[152:155], v[140:143]
    v_fmac_f32_dpp v168, v133, v165 quad_perm:[1,1,1,1] row_mask:0xf bank_mask:0xf
    v_fmac_f32_dpp v167, v137, v165 quad_perm:[1,1,1,1] row_mask:0xf bank_mask:0xf
    s_waitcnt lgkmcnt(0)
    v_readfirstlane_b32 s60, v175
    s_waitcnt vmcnt(19)
    buffer_load_dwordx4 v[88:91], v169, s[24:27], s32 offen offset:1024 nt
    v_mfma_f32_16x16x32_bf16 v[144:147], v[124:127], v[148:151], 0
    v_fmac_f32_dpp v168, v134, v165 quad_perm:[2,2,2,2] row_mask:0xf bank_mask:0xf
    v_fmac_f32_dpp v167, v138, v165 quad_perm:[2,2,2,2] row_mask:0xf bank_mask:0xf
    s_lshr_b32 s22, s60, 2
    s_and_b32 s60, s60, 3
    s_cmp_ge_u32 s61, s22
    s_cselect_b32 s60, 1, s60
    s_cmp_eq_u32 s61, 32
    s_cselect_b32 s35, 4, s60
    s_waitcnt vmcnt(19)
    buffer_load_dwordx4 v[92:95], v169, s[24:27], s32 offen offset:2048 nt
    v_mfma_f32_16x16x32_bf16 v[144:147], v[128:131], v[152:155], v[144:147]
    v_fmac_f32_dpp v168, v135, v165 quad_perm:[3,3,3,3] row_mask:0xf bank_mask:0xf
    v_fmac_f32_dpp v167, v139, v165 quad_perm:[3,3,3,3] row_mask:0xf bank_mask:0xf
    v_cndmask_b32 v168, v168, v167, s[50:51]
    s_cmp_eq_u32 s35, 1
    s_cbranch_scc1 L_p1_1
    s_cmp_eq_u32 s35, 0
    s_cbranch_scc1 L_p1_0
    s_cmp_eq_u32 s35, 2
    s_cbranch_scc1 L_p1_2
    s_branch L_mid
L_p1_0:
    s_waitcnt vmcnt(18)
    buffer_load_dwordx4 v[96:99], v169, s[24:27], s32 offen offset:3072 nt
    v_mfma_f32_16x16x32_bf16 v[132:135], v[4:7], v[148:151], 0
    s_xor_b32 s32, s33, 0x7000
    v_mul_f32_dpp v166, v140, v165 quad_perm:[0,0,0,0] row_mask:0xf bank_mask:0xf
    v_mul_f32_dpp v167, v144, v165 quad_perm:[0,0,0,0] row_mask:0xf bank_mask:0xf
    s_waitcnt vmcnt(18)
    buffer_load_dwordx4 v[100:103], v169, s[24:27], s32 offen offset:0 nt
    v_mfma_f32_16x16x32_bf16 v[132:135], v[8:11], v[152:155], v[132:135]
    v_fmac_f32_dpp v166, v141, v165 quad_perm:[1,1,1,1] row_mask:0xf bank_mask:0xf
    v_fmac_f32_dpp v167, v145, v165 quad_perm:[1,1,1,1] row_mask:0xf bank_mask:0xf
    s_add_u32 s61, s61, 1
    s_bitcmp1_b64 s[56:57], s61
    s_cbranch_scc1 L_p1_0_ev
L_p1_0_ev_back:
    s_waitcnt vmcnt(18)
    buffer_load_dwordx4 v[104:107], v169, s[24:27], s32 offen offset:1024 nt
    v_mfma_f32_16x16x32_bf16 v[136:139], v[12:15], v[148:151], 0
    v_fmac_f32_dpp v166, v142, v165 quad_perm:[2,2,2,2] row_mask:0xf bank_mask:0xf
    v_fmac_f32_dpp v167, v146, v165 quad_perm:[2,2,2,2] row_mask:0xf bank_mask:0xf
    s_waitcnt vmcnt(18)
    buffer_load_dwordx4 v[108:111], v169, s[24:27], s32 offen offset:2048 nt
    v_mfma_f32_16x16x32_bf16 v[136:139], v[16:19], v[152:155], v[136:139]
    v_fmac_f32_dpp v166, v143, v165 quad_perm:[3,3,3,3] row_mask:0xf bank_mask:0xf
    v_fmac_f32_dpp v167, v147, v165 quad_perm:[3,3,3,3] row_mask:0xf bank_mask:0xf
    v_cndmask_b32 v168, v168, v166, s[52:53]
    v_cndmask_b32 v168, v168, v167, s[54:55]
    ds_write_b32 v171, v168 offset:0
    v_max_f32 v164, v164, v168
    s_waitcnt vmcnt(18)
    buffer_load_dwordx4 v[112:115], v169, s[24:27], s32 offen offset:3072 nt
    v_mfma_f32_16x16x32_bf16 v[140:143], v[20:23], v[148:151], 0
    s_xor_b32 s32, s33, 0xf000
    s_add_u32 s34, s34, 1
    s_or_b32 s38, s34, 16
    v_mul_f32_dpp v168, v132, v165 quad_perm:[0,0,0,0] row_mask:0xf bank_mask:0xf
    v_mul_f32_dpp v167, v136, v165 quad_perm:[0,0,0,0] row_mask:0xf bank_mask:0xf
    s_waitcnt vmcnt(18)
    buffer_load_dwordx4 v[116:119], v169, s[24:27], s32 offen offset:0 nt
    v_mfma_f32_16x16x32_bf16 v[140:143], v[24:27], v[152:155], v[140:143]
    s_ff1_i32_b32 s38, s38
    s_mul_i32 s38, s38, 11
    v_fmac_f32_dpp v168, v133, v165 quad_perm:[1,1,1,1] row_mask:0xf bank_mask:0xf
    v_fmac_f32_dpp v167, v137, v165 quad_perm:[1,1,1,1] row_mask:0xf bank_mask:0xf
    s_waitcnt vmcnt(18)
    buffer_load_dwordx4 v[120:123], v169, s[24:27], s32 offen offset:1024 nt
    v_mfma_f32_16x16x32_bf16 v[144:147], v[28:31], v[148:151], 0
    s_lshr_b64 s[38:39], s[36:37], s38
    s_and_b32 s38, s38, 0x7ff
    v_fmac_f32_dpp v168, v134, v165 quad_perm:[2,2,2,2] row_mask:0xf bank_mask:0xf
    v_fmac_f32_dpp v167, v138, v165 quad_perm:[2,2,2,2] row_mask:0xf bank_mask:0xf
    s_waitcnt vmcnt(18)
    buffer_load_dwordx4 v[124:127], v169, s[24:27], s32 offen offset:2048 nt
    v_mfma_f32_16x16x32_bf16 v[144:147], v[32:35], v[152:155], v[144:147]
    s_lshl_b32 s38, s38, 12
    s_xor_b32 s33, s33, s38
    v_fmac_f32_dpp v168, v135, v165 quad_perm:[3,3,3,3] row_mask:0xf bank_mask:0xf
    v_fmac_f32_dpp v167, v139, v165 quad_perm:[3,3,3,3] row_mask:0xf bank_mask:0xf
    v_cndmask_b32 v168, v168, v167, s[50:51]
    s_waitcnt vmcnt(18)
    buffer_load_dwordx4 v[128:131], v169, s[24:27], s32 offen offset:3072 nt
    v_mfma_f32_16x16x32_bf16 v[132:135], v[36:39], v[148:151], 0
    s_mov_b32 s32, s33
    s_cmp_eq_u32 s61, 32
    s_cbranch_scc1 L_p1_0_toV
L_p1_0_toV_back:
    v_mul_f32_dpp v166, v140, v165 quad_perm:[0,0,0,0] row_mask:0xf bank_mask:0xf
    v_mul_f32_dpp v167, v144, v165 quad_perm:[0,0,0,0] row_mask:0xf bank_mask:0xf
    s_waitcnt vmcnt(18)
    buffer_load_dwordx4 v[4:7], v169, s[24:27], s32 offen offset:0 nt
    v_mfma_f32_16x16x32_bf16 v[132:135], v[40:43], v[152:155], v[132:135]
    v_fmac_f32_dpp v166, v141, v165 quad_perm:[1,1,1,1] row_mask:0xf bank_mask:0xf
    v_fmac_f32_dpp v167, v145, v165 quad_perm:[1,1,1,1] row_mask:0xf bank_mask:0xf
    s_waitcnt vmcnt(18)
    buffer_load_dwordx4 v[8:11], v169, s[24:27], s32 offen offset:1024 nt
    v_mfma_f32_16x16x32_bf16 v[136:139], v[44:47], v[148:151], 0
    v_fmac_f32_dpp v166, v142, v165 quad_perm:[2,2,2,2] row_mask:0xf bank_mask:0xf
    v_fmac_f32_dpp v167, v146, v165 quad_perm:[2,2,2,2] row_mask:0xf bank_mask:0xf
    s_waitcnt vmcnt(18)
    buffer_load_dwordx4 v[12:15], v169, s[24:27], s32 offen offset:2048 nt
    v_mfma_f32_16x16x32_bf16 v[136:139], v[48:51], v[152:155], v[136:139]
    v_fmac_f32_dpp v166, v143, v165 quad_perm:[3,3,3,3] row_mask:0xf bank_mask:0xf
    v_fmac_f32_dpp v167, v147, v165 quad_perm:[3,3,3,3] row_mask:0xf bank_mask:0xf
    v_cndmask_b32 v168, v168, v166, s[52:53]
    v_cndmask_b32 v168, v168, v167, s[54:55]
    ds_write_b32 v171, v168 offset:256
    v_max_f32 v164, v164, v168
    s_waitcnt vmcnt(18)
    buffer_load_dwordx4 v[16:19], v169, s[24:27], s32 offen offset:3072 nt
    v_mfma_f32_16x16x32_bf16 v[140:143], v[52:55], v[148:151], 0
    s_xor_b32 s32, s33, 0x8000
    v_mul_f32_dpp v168, v132, v165 quad_perm:[0,0,0,0] row_mask:0xf bank_mask:0xf
    v_mul_f32_dpp v167, v136, v165 quad_perm:[0,0,0,0] row_mask:0xf bank_mask:0xf
    s_waitcnt vmcnt(18)
    buffer_load_dwordx4 v[20:23], v169, s[24:27], s32 offen offset:0 nt
    v_mfma_f32_16x16x32_bf16 v[140:143], v[56:59], v[152:155], v[140:143]
    v_fmac_f32_dpp v168, v133, v165 quad_perm:[1,1,1,1] row_mask:0xf bank_mask:0xf
    v_fmac_f32_dpp v167, v137, v165 quad_perm:[1,1,1,1] row_mask:0xf bank_mask:0xf
    s_waitcnt vmcnt(18)
    buffer_load_dwordx4 v[24:27], v169, s[24:27], s32 offen offset:1024 nt
    v_mfma_f32_16x16x32_bf16 v[144:147], v[60:63], v[148:151], 0
    v_fmac_f32_dpp v168, v134, v165 quad_perm:[2,2,2,2] row_mask:0xf bank_mask:0xf
    v_fmac_f32_dpp v167, v138, v165 quad_perm:[2,2,2,2] row_mask:0xf bank_mask:0xf
    s_waitcnt vmcnt(18)
    buffer_load_dwordx4 v[28:31], v169, s[24:27], s32 offen offset:2048 nt
    v_mfma_f32_16x16x32_bf16 v[144:147], v[64:67], v[152:155], v[144:147]
    v_fmac_f32_dpp v168, v135, v165 quad_perm:[3,3,3,3] row_mask:0xf bank_mask:0xf
    v_fmac_f32_dpp v167, v139, v165 quad_perm:[3,3,3,3] row_mask:0xf bank_mask:0xf
    v_cndmask_b32 v168, v168, v167, s[50:51]
    s_waitcnt vmcnt(18)
    buffer_load_dwordx4 v[32:35], v169, s[24:27], s32 offen offset:3072 nt
    v_mfma_f32_16x16x32_bf16 v[132:135], v[68:71], v[148:151], 0
    s_xor_b32 s32, s33, 0x1000
    v_mul_f32_dpp v166, v140, v165 quad_perm:[0,0,0,0] row_mask:0xf bank_mask:0xf
    v_mul_f32_dpp v167, v144, v165 quad_perm:[0,0,0,0] row_mask:0xf bank_mask:0xf
    s_waitcnt vmcnt(18)
    buffer_load_dwordx4 v[36:39], v169, s[24:27], s32 offen offset:0 nt
    v_mfma_f32_16x16x32_bf16 v[132:135], v[72:75], v[152:155], v[132:135]
    v_fmac_f32_dpp v166, v141, v165 quad_perm:[1,1,1,1] row_mask:0xf bank_mask:0xf
    v_fmac_f32_dpp v167, v145, v165 quad_perm:[1,1,1,1] row_mask:0xf bank_mask:0xf
    s_waitcnt vmcnt(18)
    buffer_load_dwordx4 v[40:43], v169, s[24:27], s32 offen offset:1024 nt
    v_mfma_f32_16x16x32_bf16 v[136:139], v[76:79], v[148:151], 0
    v_fmac_f32_dpp v166, v142, v165 quad_perm:[2,2,2,2] row_mask:0xf bank_mask:0xf
    v_fmac_f32_dpp v167, v146, v165 quad_perm:[2,2,2,2] row_mask:0xf bank_mask:0xf
    s_waitcnt vmcnt(18)
    buffer_load_dwordx4 v[44:47], v169, s[24:27], s32 offen offset:2048 nt
    v_mfma_f32_16x16x32_bf16 v[136:139], v[80:83], v[152:155], v[136:139]
    v_fmac_f32_dpp v166, v143, v165 quad_perm:[3,3,3,3] row_mask:0xf bank_mask:0xf
    v_fmac_f32_dpp v167, v147, v165 quad_perm:[3,3,3,3] row_mask:0xf bank_mask:0xf
    v_cndmask_b32 v168, v168, v166, s[52:53]
    v_cndmask_b32 v168, v168, v167, s[54:55]
    ds_write_b32 v171, v168 offset:512
    v_max_f32 v164, v164, v168
    s_waitcnt vmcnt(18)
    buffer_load_dwordx4 v[48:51], v169, s[24:27], s32 offen offset:3072 nt
    v_mfma_f32_16x16x32_bf16 v[140:143], v[84:87], v[148:151], 0
    s_xor_b32 s32, s33, 0x9000
    v_mul_f32_dpp v168, v132, v165 quad_perm:[0,0,0,0] row_mask:0xf bank_mask:0xf
    v_mul_f32_dpp v167, v136, v165 quad_perm:[0,0,0,0] row_mask:0xf bank_mask:0xf
    s_waitcnt vmcnt(18)
    buffer_load_dwordx4 v[52:55], v169, s[24:27], s32 offen offset:0 nt
    v_mfma_f32_16x16x32_bf16 v[140:143], v[88:91], v[152:155], v[140:143]
    v_fmac_f32_dpp v168, v133, v165 quad_perm:[1,1,1,1] row_mask:0xf bank_mask:0xf
    v_fmac_f32_dpp v167, v137, v165 quad_perm:[1,1,1,1] row_mask:0xf bank_mask:0xf
    s_waitcnt vmcnt(18)
    buffer_load_dwordx4 v[56:59], v169, s[24:27], s32 offen offset:1024 nt
    v_mfma_f32_16x16x32_bf16 v[144:147], v[92:95], v[148:151], 0
    v_fmac_f32_dpp v168, v134, v165 quad_perm:[2,2,2,2] row_mask:0xf bank_mask:0xf
    v_fmac_f32_dpp v167, v138, v165 quad_perm:[2,2,2,2] row_mask:0xf bank_mask:0xf
    s_waitcnt vmcnt(18)
    buffer_load_dwordx4 v[60:63], v169, s[24:27], s32 offen offset:2048 nt
    v_mfma_f32_16x16x32_bf16 v[144:147], v[96:99], v[152:155], v[144:147]
    v_fmac_f32_dpp v168, v135, v165 quad_perm:[3,3,3,3] row_mask:0xf bank_mask:0xf
    v_fmac_f32_dpp v167, v139, v165 quad_perm:[3,3,3,3] row_mask:0xf bank_mask:0xf
    v_cndmask_b32 v168, v168, v167, s[50:51]
    s_waitcnt vmcnt(18)
    buffer_load_dwordx4 v[64:67], v169, s[24:27], s32 offen offset:3072 nt
    v_mfma_f32_16x16x32_bf16 v[132:135], v[100:103], v[148:151], 0
    s_xor_b32 s32, s33, 0x6000
    v_mul_f32_dpp v166, v140, v165 quad_perm:[0,0,0,0] row_mask:0xf bank_mask:0xf
    v_mul_f32_dpp v167, v144, v165 quad_perm:[0,0,0,0] row_mask:0xf bank_mask:0xf
    s_waitcnt vmcnt(18)
    buffer_load_dwordx4 v[68:71], v169, s[24:27], s32 offen offset:0 nt
    v_mfma_f32_16x16x32_bf16 v[132:135], v[104:107], v[152:155], v[132:135]
    v_fmac_f32_dpp v166, v141, v165 quad_perm:[1,1,1,1] row_mask:0xf bank_mask:0xf
    v_fmac_f32_dpp v167, v145, v165 quad_perm:[1,1,1,1] row_mask:0xf bank_mask:0xf
    s_waitcnt vmcnt(18)
    buffer_load_dwordx4 v[72:75], v169, s[24:27], s32 offen offset:1024 nt
    v_mfma_f32_16x16x32_bf16 v[136:139], v[108:111], v[148:151], 0
    v_fmac_f32_dpp v166, v142, v165 quad_perm:[2,2,2,2] row_mask:0xf bank_mask:0xf
    v_fmac_f32_dpp v167, v146, v165 quad_perm:[2,2,2,2] row_mask:0xf bank_mask:0xf
    s_waitcnt vmcnt(18)
    buffer_load_dwordx4 v[76:79], v169, s[24:27], s32 offen offset:2048 nt
    v_mfma_f32_16x16x32_bf16 v[136:139], v[112:115], v[152:155], v[136:139]
    v_fmac_f32_dpp v166, v143, v165 quad_perm:[3,3,3,3] row_mask:0xf bank_mask:0xf
    v_fmac_f32_dpp v167, v147, v165 quad_perm:[3,3,3,3] row_mask:0xf bank_mask:0xf
    v_cndmask_b32 v168, v168, v166, s[52:53]
    v_cndmask_b32 v168, v168, v167, s[54:55]
    ds_write_b32 v171, v168 offset:768
    v_max_f32 v164, v164, v168
    ds_read_b32 v175, v176 offset:34304
    s_waitcnt vmcnt(18)
    buffer_load_dwordx4 v[80:83], v169, s[24:27], s32 offen offset:3072 nt
    v_mfma_f32_16x16x32_bf16 v[140:143], v[116:119], v[148:151], 0
    s_xor_b32 s32, s33, 0xe000
    v_mul_f32_dpp v168, v132, v165 quad_perm:[0,0,0,0] row_mask:0xf bank_mask:0xf
    v_mul_f32_dpp v167, v136, v165 quad_perm:[0,0,0,0] row_mask:0xf bank_mask:0xf
    v_add_u32 v171, 1024, v171
    s_waitcnt vmcnt(18)
    buffer_load_dwordx4 v[84:87], v169, s[24:27], s32 offen offset:0 nt
    v_mfma_f32_16x16x32_bf16 v[140:143], v[120:123], v[152:155], v[140:143]
    v_fmac_f32_dpp v168, v133, v165 quad_perm:[1,1,1,1] row_mask:0xf bank_mask:0xf
    v_fmac_f32_dpp v167, v137, v165 quad_perm:[1,1,1,1] row_mask:0xf bank_mask:0xf
    s_waitcnt lgkmcnt(0)
    v_readfirstlane_b32 s60, v175
    s_waitcnt vmcnt(18)
    buffer_load_dwordx4 v[88:91], v169, s[24:27], s32 offen offset:1024 nt
    v_mfma_f32_16x16x32_bf16 v[144:147], v[124:127], v[148:151], 0
    v_fmac_f32_dpp v168, v134, v165 quad_perm:[2,2,2,2] row_mask:0xf bank_mask:0xf
    v_fmac_f32_dpp v167, v138, v165 quad_perm:[2,2,2,2] row_mask:0xf bank_mask:0xf
    s_lshr_b32 s22, s60, 2
    s_and_b32 s60, s60, 3
    s_cmp_ge_u32 s61, s22
    s_cselect_b32 s60, 1, s60
    s_cmp_eq_u32 s61, 32
    s_cselect_b32 s35, 4, s60
    s_waitcnt vmcnt(18)
    buffer_load_dwordx4 v[92:95], v169, s[24:27], s32 offen offset:2048 nt
    v_mfma_f32_16x16x32_bf16 v[144:147], v[128:131], v[152:155], v[144:147]
    v_fmac_f32_dpp v168, v135, v165 quad_perm:[3,3,3,3] row_mask:0xf bank_mask:0xf
    v_fmac_f32_dpp v167, v139, v165 quad_perm:[3,3,3,3] row_mask:0xf bank_mask:0xf
    v_cndmask_b32 v168, v168, v167, s[50:51]
    s_cmp_eq_u32 s35, 0
    s_cbranch_scc1 L_p1_0
    s_cmp_eq_u32 s35, 1
    s_cbranch_scc1 L_p1_1
    s_cmp_eq_u32 s35, 2
    s_cbranch_scc1 L_p1_2
    s_branch L_mid
L_p1_2:
    s_waitcnt vmcnt(22)
    buffer_load_dwordx4 v[96:99], v169, s[24:27], s32 offen offset:3072 nt
    v_mfma_f32_16x16x32_bf16 v[132:135], v[4:7], v[148:151], 0
    s_xor_b32 s32, s33, 0x7000
    v_mul_f32_dpp v166, v140, v165 quad_perm:[0,0,0,0] row_mask:0xf bank_mask:0xf
    v_mul_f32_dpp v167, v144, v165 quad_perm:[0,0,0,0] row_mask:0xf bank_mask:0xf
    s_waitcnt vmcnt(22)
    buffer_load_dwordx4 v[100:103], v169, s[24:27], s32 offen offset:0 nt
    v_mfma_f32_16x16x32_bf16 v[132:135], v[8:11], v[152:155], v[132:135]
    v_fmac_f32_dpp v166, v141, v165 quad_perm:[1,1,1,1] row_mask:0xf bank_mask:0xf
    v_fmac_f32_dpp v167, v145, v165 quad_perm:[1,1,1,1] row_mask:0xf bank_mask:0xf
    s_add_u32 s61, s61, 1
    s_bitcmp1_b64 s[56:57], s61
    s_cbranch_scc1 L_p1_2_ev
L_p1_2_ev_back:
    s_waitcnt vmcnt(22)
    buffer_load_dwordx4 v[104:107], v169, s[24:27], s32 offen offset:1024 nt
    v_mfma_f32_16x16x32_bf16 v[136:139], v[12:15], v[148:151], 0
    v_fmac_f32_dpp v166, v142, v165 quad_perm:[2,2,2,2] row_mask:0xf bank_mask:0xf
    v_fmac_f32_dpp v167, v146, v165 quad_perm:[2,2,2,2] row_mask:0xf bank_mask:0xf
    s_waitcnt vmcnt(22)
    buffer_load_dwordx4 v[108:111], v169, s[24:27], s32 offen offset:2048 nt
    v_mfma_f32_16x16x32_bf16 v[136:139], v[16:19], v[152:155], v[136:139]
    v_fmac_f32_dpp v166, v143, v165 quad_perm:[3,3,3,3] row_mask:0xf bank_mask:0xf
    v_fmac_f32_dpp v167, v147, v165 quad_perm:[3,3,3,3] row_mask:0xf bank_mask:0xf
    v_cndmask_b32 v168, v168, v166, s[52:53]
    v_cndmask_b32 v168, v168, v167, s[54:55]
    ds_write_b32 v171, v168 offset:0
    v_max_f32 v164, v164, v168
    s_waitcnt vmcnt(22)
    buffer_load_dwordx4 v[112:115], v169, s[24:27], s32 offen offset:3072 nt
    v_mfma_f32_16x16x32_bf16 v[140:143], v[20:23], v[148:151], 0
    s_xor_b32 s32, s33, 0xf000
    s_add_u32 s34, s34, 1
    s_or_b32 s38, s34, 16
    v_mul_f32_dpp v168, v132, v165 quad_perm:[0,0,0,0] row_mask:0xf bank_mask:0xf
    v_mul_f32_dpp v167, v136, v165 quad_perm:[0,0,0,0] row_mask:0xf bank_mask:0xf
    s_waitcnt vmcnt(22)
    buffer_load_dwordx4 v[116:119], v169, s[24:27], s32 offen offset:0 nt
    v_mfma_f32_16x16x32_bf16 v[140:143], v[24:27], v[152:155], v[140:143]
    s_ff1_i32_b32 s38, s38
    s_mul_i32 s38, s38, 11
    v_fmac_f32_dpp v168, v133, v165 quad_perm:[1,1,1,1] row_mask:0xf bank_mask:0xf
    v_fmac_f32_dpp v167, v137, v165 quad_perm:[1,1,1,1] row_mask:0xf bank_mask:0xf
    s_waitcnt vmcnt(22)
    buffer_load_dwordx4 v[120:123], v169, s[24:27], s32 offen offset:1024 nt
    v_mfma_f32_16x16x32_bf16 v[144:147], v[28:31], v[148:151], 0
    s_lshr_b64 s[38:39], s[36:37], s38
    s_and_b32 s38, s38, 0x7ff
    v_fmac_f32_dpp v168, v134, v165 quad_perm:[2,2,2,2] row_mask:0xf bank_mask:0xf
    v_fmac_f32_dpp v167, v138, v165 quad_perm:[2,2,2,2] row_mask:0xf bank_mask:0xf
    s_waitcnt vmcnt(22)
    buffer_load_dwordx4 v[124:127], v169, s[24:27], s32 offen offset:2048 nt
    v_mfma_f32_16x16x32_bf16 v[144:147], v[32:35], v[152:155], v[144:147]
    s_lshl_b32 s38, s38, 12
    s_xor_b32 s33, s33, s38
    v_fmac_f32_dpp v168, v135, v165 quad_perm:[3,3,3,3] row_mask:0xf bank_mask:0xf
    v_fmac_f32_dpp v167, v139, v165 quad_perm:[3,3,3,3] row_mask:0xf bank_mask:0xf
    v_cndmask_b32 v168, v168, v167, s[50:51]
    s_waitcnt vmcnt(22)
    buffer_load_dwordx4 v[128:131], v169, s[24:27], s32 offen offset:3072 nt
    v_mfma_f32_16x16x32_bf16 v[132:135], v[36:39], v[148:151], 0
    s_mov_b32 s32, s33
    s_cmp_eq_u32 s61, 32
    s_cbranch_scc1 L_p1_2_toV
L_p1_2_toV_back:
    v_mul_f32_dpp v166, v140, v165 quad_perm:[0,0,0,0] row_mask:0xf bank_mask:0xf
    v_mul_f32_dpp v167, v144, v165 quad_perm:[0,0,0,0] row_mask:0xf bank_mask:0xf
    s_waitcnt vmcnt(22)
    buffer_load_dwordx4 v[4:7], v169, s[24:27], s32 offen offset:0 nt
    v_mfma_f32_16x16x32_bf16 v[132:135], v[40:43], v[152:155], v[132:135]
    v_fmac_f32_dpp v166, v141, v165 quad_perm:[1,1,1,1] row_mask:0xf bank_mask:0xf
    v_fmac_f32_dpp v167, v145, v165 quad_perm:[1,1,1,1] row_mask:0xf bank_mask:0xf
    s_waitcnt vmcnt(22)
    buffer_load_dwordx4 v[8:11], v169, s[24:27], s32 offen offset:1024 nt
    v_mfma_f32_16x16x32_bf16 v[136:139], v[44:47], v[148:151], 0
    v_fmac_f32_dpp v166, v142, v165 quad_perm:[2,2,2,2] row_mask:0xf bank_mask:0xf
    v_fmac_f32_dpp v167, v146, v165 quad_perm:[2,2,2,2] row_mask:0xf bank_mask:0xf
    s_waitcnt vmcnt(22)
    buffer_load_dwordx4 v[12:15], v169, s[24:27], s32 offen offset:2048 nt
    v_mfma_f32_16x16x32_bf16 v[136:139], v[48:51], v[152:155], v[136:139]
    v_fmac_f32_dpp v166, v143, v165 quad_perm:[3,3,3,3] row_mask:0xf bank_mask:0xf
    v_fmac_f32_dpp v167, v147, v165 quad_perm:[3,3,3,3] row_mask:0xf bank_mask:0xf
    v_cndmask_b32 v168, v168, v166, s[52:53]
    v_cndmask_b32 v168, v168, v167, s[54:55]
    ds_write_b32 v171, v168 offset:256
    v_max_f32 v164, v164, v168
    s_waitcnt vmcnt(22)
    buffer_load_dwordx4 v[16:19], v169, s[24:27], s32 offen offset:3072 nt
    v_mfma_f32_16x16x32_bf16 v[140:143], v[52:55], v[148:151], 0
    s_xor_b32 s32, s33, 0x8000
    v_mul_f32_dpp v168, v132, v165 quad_perm:[0,0,0,0] row_mask:0xf bank_mask:0xf
    v_mul_f32_dpp v167, v136, v165 quad_perm:[0,0,0,0] row_mask:0xf bank_mask:0xf
    s_waitcnt vmcnt(22)
    buffer_load_dwordx4 v[20:23], v169, s[24:27], s32 offen offset:0 nt
    v_mfma_f32_16x16x32_bf16 v[140:143], v[56:59], v[152:155], v[140:143]
    v_fmac_f32_dpp v168, v133, v165 quad_perm:[1,1,1,1] row_mask:0xf bank_mask:0xf
    v_fmac_f32_dpp v167, v137, v165 quad_perm:[1,1,1,1] row_mask:0xf bank_mask:0xf
    s_waitcnt vmcnt(22)
    buffer_load_dwordx4 v[24:27], v169, s[24:27], s32 offen offset:1024 nt
    v_mfma_f32_16x16x32_bf16 v[144:147], v[60:63], v[148:151], 0
    v_fmac_f32_dpp v168, v134, v165 quad_perm:[2,2,2,2] row_mask:0xf bank_mask:0xf
    v_fmac_f32_dpp v167, v138, v165 quad_perm:[2,2,2,2] row_mask:0xf bank_mask:0xf
    s_waitcnt vmcnt(22)
    buffer_load_dwordx4 v[28:31], v169, s[24:27], s32 offen offset:2048 nt
    v_mfma_f32_16x16x32_bf16 v[144:147], v[64:67], v[152:155], v[144:147]
    v_fmac_f32_dpp v168, v135, v165 quad_perm:[3,3,3,3] row_mask:0xf bank_mask:0xf
    v_fmac_f32_dpp v167, v139, v165 quad_perm:[3,3,3,3] row_mask:0xf bank_mask:0xf
    v_cndmask_b32 v168, v168, v167, s[50:51]
    s_waitcnt vmcnt(22)
    buffer_load_dwordx4 v[32:35], v169, s[24:27], s32 offen offset:3072 nt
    v_mfma_f32_16x16x32_bf16 v[132:135], v[68:71], v[148:151], 0
    s_xor_b32 s32, s33, 0x1000
    v_mul_f32_dpp v166, v140, v165 quad_perm:[0,0,0,0] row_mask:0xf bank_mask:0xf
    v_mul_f32_dpp v167, v144, v165 quad_perm:[0,0,0,0] row_mask:0xf bank_mask:0xf
    s_waitcnt vmcnt(22)
    buffer_load_dwordx4 v[36:39], v169, s[24:27], s32 offen offset:0 nt
    v_mfma_f32_16x16x32_bf16 v[132:135], v[72:75], v[152:155], v[132:135]
    v_fmac_f32_dpp v166, v141, v165 quad_perm:[1,1,1,1] row_mask:0xf bank_mask:0xf
    v_fmac_f32_dpp v167, v145, v165 quad_perm:[1,1,1,1] row_mask:0xf bank_mask:0xf
    s_waitcnt vmcnt(22)
    buffer_load_dwordx4 v[40:43], v169, s[24:27], s32 offen offset:1024 nt
    v_mfma_f32_16x16x32_bf16 v[136:139], v[76:79], v[148:151], 0
    v_fmac_f32_dpp v166, v142, v165 quad_perm:[2,2,2,2] row_mask:0xf bank_mask:0xf
    v_fmac_f32_dpp v167, v146, v165 quad_perm:[2,2,2,2] row_mask:0xf bank_mask:0xf
    s_waitcnt vmcnt(22)
    buffer_load_dwordx4 v[44:47], v169, s[24:27], s32 offen offset:2048 nt
    v_mfma_f32_16x16x32_bf16 v[136:139], v[80:83], v[152:155], v[136:139]
    v_fmac_f32_dpp v166, v143, v165 quad_perm:[3,3,3,3] row_mask:0xf bank_mask:0xf
    v_fmac_f32_dpp v167, v147, v165 quad_perm:[3,3,3,3] row_mask:0xf bank_mask:0xf
    v_cndmask_b32 v168, v168, v166, s[52:53]
    v_cndmask_b32 v168, v168, v167, s[54:55]
    ds_write_b32 v171, v168 offset:512
    v_max_f32 v164, v164, v168
    s_waitcnt vmcnt(22)
    buffer_load_dwordx4 v[48:51], v169, s[24:27], s32 offen offset:3072 nt
    v_mfma_f32_16x16x32_bf16 v[140:143], v[84:87], v[148:151], 0
    s_xor_b32 s32, s33, 0x9000
    v_mul_f32_dpp v168, v132, v165 quad_perm:[0,0,0,0] row_mask:0xf bank_mask:0xf
    v_mul_f32_dpp v167, v136, v165 quad_perm:[0,0,0,0] row_mask:0xf bank_mask:0xf
    s_waitcnt vmcnt(22)
    buffer_load_dwordx4 v[52:55], v169, s[24:27], s32 offen offset:0 nt
    v_mfma_f32_16x16x32_bf16 v[140:143], v[88:91], v[152:155], v[140:143]
    v_fmac_f32_dpp v168, v133, v165 quad_perm:[1,1,1,1] row_mask:0xf bank_mask:0xf
    v_fmac_f32_dpp v167, v137, v165 quad_perm:[1,1,1,1] row_mask:0xf bank_mask:0xf
    s_waitcnt vmcnt(22)
    buffer_load_dwordx4 v[56:59], v169, s[24:27], s32 offen offset:1024 nt
    v_mfma_f32_16x16x32_bf16 v[144:147], v[92:95], v[148:151], 0
    v_fmac_f32_dpp v168, v134, v165 quad_perm:[2,2,2,2] row_mask:0xf bank_mask:0xf
    v_fmac_f32_dpp v167, v138, v165 quad_perm:[2,2,2,2] row_mask:0xf bank_mask:0xf
    s_waitcnt vmcnt(22)
    buffer_load_dwordx4 v[60:63], v169, s[24:27], s32 offen offset:2048 nt
    v_mfma_f32_16x16x32_bf16 v[144:147], v[96:99], v[152:155], v[144:147]
    v_fmac_f32_dpp v168, v135, v165 quad_perm:[3,3,3,3] row_mask:0xf bank_mask:0xf
    v_fmac_f32_dpp v167, v139, v165 quad_perm:[3,3,3,3] row_mask:0xf bank_mask:0xf
    v_cndmask_b32 v168, v168, v167, s[50:51]
    s_waitcnt vmcnt(22)
    buffer_load_dwordx4 v[64:67], v169, s[24:27], s32 offen offset:3072 nt
    v_mfma_f32_16x16x32_bf16 v[132:135], v[100:103], v[148:151], 0
    s_xor_b32 s32, s33, 0x6000
    v_mul_f32_dpp v166, v140, v165 quad_perm:[0,0,0,0] row_mask:0xf bank_mask:0xf
    v_mul_f32_dpp v167, v144, v165 quad_perm:[0,0,0,0] row_mask:0xf bank_mask:0xf
    s_waitcnt vmcnt(22)
    buffer_load_dwordx4 v[68:71], v169, s[24:27], s32 offen offset:0 nt
    v_mfma_f32_16x16x32_bf16 v[132:135], v[104:107], v[152:155], v[132:135]
    v_fmac_f32_dpp v166, v141, v165 quad_perm:[1,1,1,1] row_mask:0xf bank_mask:0xf
    v_fmac_f32_dpp v167, v145, v165 quad_perm:[1,1,1,1] row_mask:0xf bank_mask:0xf
    s_waitcnt vmcnt(22)
    buffer_load_dwordx4 v[72:75], v169, s[24:27], s32 offen offset:1024 nt
    v_mfma_f32_16x16x32_bf16 v[136:139], v[108:111], v[148:151], 0
    v_fmac_f32_dpp v166, v142, v165 quad_perm:[2,2,2,2] row_mask:0xf bank_mask:0xf
    v_fmac_f32_dpp v167, v146, v165 quad_perm:[2,2,2,2] row_mask:0xf bank_mask:0xf
    s_waitcnt vmcnt(22)
    buffer_load_dwordx4 v[76:79], v169, s[24:27], s32 offen offset:2048 nt
    v_mfma_f32_16x16x32_bf16 v[136:139], v[112:115], v[152:155], v[136:139]
    v_fmac_f32_dpp v166, v143, v165 quad_perm:[3,3,3,3] row_mask:0xf bank_mask:0xf
    v_fmac_f32_dpp v167, v147, v165 quad_perm:[3,3,3,3] row_mask:0xf bank_mask:0xf
    v_cndmask_b32 v168, v168, v166, s[52:53]
    v_cndmask_b32 v168, v168, v167, s[54:55]
    ds_write_b32 v171, v168 offset:768
    v_max_f32 v164, v164, v168
    ds_read_b32 v175, v176 offset:34304
    s_waitcnt vmcnt(22)
    buffer_load_dwordx4 v[80:83], v169, s[24:27], s32 offen offset:3072 nt
    v_mfma_f32_16x16x32_bf16 v[140:143], v[116:119], v[148:151], 0
    s_xor_b32 s32, s33, 0xe000
    v_mul_f32_dpp v168, v132, v165 quad_perm:[0,0,0,0] row_mask:0xf bank_mask:0xf
    v_mul_f32_dpp v167, v136, v165 quad_perm:[0,0,0,0] row_mask:0xf bank_mask:0xf
    v_add_u32 v171, 1024, v171
    s_waitcnt vmcnt(22)
    buffer_load_dwordx4 v[84:87], v169, s[24:27], s32 offen offset:0 nt
    v_mfma_f32_16x16x32_bf16 v[140:143], v[120:123], v[152:155], v[140:143]
    v_fmac_f32_dpp v168, v133, v165 quad_perm:[1,1,1,1] row_mask:0xf bank_mask:0xf
    v_fmac_f32_dpp v167, v137, v165 quad_perm:[1,1,1,1] row_mask:0xf bank_mask:0xf
    s_waitcnt lgkmcnt(0)
    v_readfirstlane_b32 s60, v175
    s_waitcnt vmcnt(22)
    buffer_load_dwordx4 v[88:91], v169, s[24:27], s32 offen offset:1024 nt
    v_mfma_f32_16x16x32_bf16 v[144:147], v[124:127], v[148:151], 0
    v_fmac_f32_dpp v168, v134, v165 quad_perm:[2,2,2,2] row_mask:0xf bank_mask:0xf
    v_fmac_f32_dpp v167, v138, v165 quad_perm:[2,2,2,2] row_mask:0xf bank_mask:0xf
    s_lshr_b32 s22, s60, 2
    s_and_b32 s60, s60, 3
    s_cmp_ge_u32 s61, s22
    s_cselect_b32 s60, 1, s60
    s_cmp_eq_u32 s61, 32
    s_cselect_b32 s35, 4, s60
    s_waitcnt vmcnt(22)
    buffer_load_dwordx4 v[92:95], v169, s[24:27], s32 offen offset:2048 nt
    v_mfma_f32_16x16x32_bf16 v[144:147], v[128:131], v[152:155], v[144:147]
    v_fmac_f32_dpp v168, v135, v165 quad_perm:[3,3,3,3] row_mask:0xf bank_mask:0xf
    v_fmac_f32_dpp v167, v139, v165 quad_perm:[3,3,3,3] row_mask:0xf bank_mask:0xf
    v_cndmask_b32 v168, v168, v167, s[50:51]
    s_cmp_eq_u32 s35, 2
    s_cbranch_scc1 L_p1_2
    s_cmp_eq_u32 s35, 0
    s_cbranch_scc1 L_p1_0
    s_cmp_eq_u32 s35, 1
    s_cbranch_scc1 L_p1_1
    s_branch L_mid
L_mid:
    s_waitcnt vmcnt(19)
    buffer_load_dwordx4 v[96:99], v169, s[24:27], s32 offen offset:3072 nt
    s_xor_b32 s32, s33, 0x7000
    s_nop 1
    v_mul_f32_dpp v166, v140, v165 quad_perm:[0,0,0,0] row_mask:0xf bank_mask:0xf
    v_mul_f32_dpp v167, v144, v165 quad_perm:[0,0,0,0] row_mask:0xf bank_mask:0xf
    s_nop 0
    v_fmac_f32_dpp v166, v141, v165 quad_perm:[1,1,1,1] row_mask:0xf bank_mask:0xf
    v_fmac_f32_dpp v167, v145, v165 quad_perm:[1,1,1,1] row_mask:0xf bank_mask:0xf
    s_nop 0
    v_fmac_f32_dpp v166, v142, v165 quad_perm:[2,2,2,2] row_mask:0xf bank_mask:0xf
    v_fmac_f32_dpp v167, v146, v165 quad_perm:[2,2,2,2] row_mask:0xf bank_mask:0xf
    s_nop 0
    v_fmac_f32_dpp v166, v143, v165 quad_perm:[3,3,3,3] row_mask:0xf bank_mask:0xf
    v_fmac_f32_dpp v167, v147, v165 quad_perm:[3,3,3,3] row_mask:0xf bank_mask:0xf
    s_nop 0
    v_cndmask_b32 v168, v168, v166, s[52:53]
    v_cndmask_b32 v168, v168, v167, s[54:55]
    s_waitcnt vmcnt(19)
    buffer_load_dwordx4 v[100:103], v169, s[24:27], s32 offen offset:0 nt
    ds_write_b32 v171, v168
    v_max_f32 v164, v164, v168
    v_subrev_u32 v171, 32512, v171
    ds_read_b32 v174, v171
    s_nop 1
    v_max_f32_dpp v164, v164, v164 quad_perm:[1,0,3,2] row_mask:0xf bank_mask:0xf
    s_nop 1
    v_max_f32_dpp v164, v164, v164 quad_perm:[2,3,0,1] row_mask:0xf bank_mask:0xf
    s_nop 1
    v_max_f32_dpp v164, v164, v164 row_half_mirror row_mask:0xf bank_mask:0xf
    v_mov_b32 v166, v164
    s_nop 1
    v_permlane16_swap_b32 v166, v164
    v_max_f32 v164, v164, v166
    v_mov_b32 v166, v164
    s_waitcnt vmcnt(19)
    buffer_load_dwordx4 v[104:107], v169, s[24:27], s32 offen offset:1024 nt
    s_nop 1
    v_permlane32_swap_b32 v166, v164
    v_max_f32 v164, v164, v166
    s_waitcnt lgkmcnt(0)
    v_sub_f32 v174, v174, v164
    v_exp_f32 v174, v174
    ds_write_b32 v171, v164 offset:33792
    v_cvt_pk_bf16_f32 v172, v174, v174
    v_cvt_pk_bf16_f32 v173, v174, v174
    s_nop 0
    v_mov_b32_dpp v172, v172 row_shr:4 row_mask:0xf bank_mask:0xa
    v_mov_b32_dpp v173, v173 row_shl:4 row_mask:0xf bank_mask:0x5
    s_waitcnt lgkmcnt(0)
    v_and_b32_dpp v132, v172, v156 quad_perm:[0,0,0,0] row_mask:0xf bank_mask:0xf
    v_and_b32_dpp v133, v172, v157 quad_perm:[0,0,0,0] row_mask:0xf bank_mask:0xf
    v_and_b32_dpp v134, v172, v158 quad_perm:[0,0,0,0] row_mask:0xf bank_mask:0xf
    v_and_b32_dpp v135, v172, v159 quad_perm:[0,0,0,0] row_mask:0xf bank_mask:0xf
    s_cmp_eq_u32 s60, 1
    s_cbranch_scc1 L_p2_1
    s_cmp_eq_u32 s60, 0
    s_cbranch_scc1 L_p2_0
    s_branch L_p2_2
L_p2_0:
    ds_read_b32 v174, v171 offset:256
    v_and_b32_dpp v136, v173, v156 quad_perm:[0,0,0,0] row_mask:0xf bank_mask:0xf
    v_and_b32_dpp v137, v173, v157 quad_perm:[0,0,0,0] row_mask:0xf bank_mask:0xf
    v_and_b32_dpp v138, v173, v158 quad_perm:[0,0,0,0] row_mask:0xf bank_mask:0xf
    v_and_b32_dpp v139, v173, v159 quad_perm:[0,0,0,0] row_mask:0xf bank_mask:0xf
    s_waitcnt vmcnt(18)
    buffer_load_dwordx4 v[108:111], v169, s[24:27], s32 offen offset:2048 nt
    v_mfma_f32_16x16x32_bf16 v[160:163], v[132:135], v[4:7], v[160:163]
    v_and_b32_dpp v132, v172, v156 quad_perm:[1,1,1,1] row_mask:0xf bank_mask:0xf
    v_and_b32_dpp v133, v172, v157 quad_perm:[1,1,1,1] row_mask:0xf bank_mask:0xf
    v_and_b32_dpp v134, v172, v158 quad_perm:[1,1,1,1] row_mask:0xf bank_mask:0xf
    v_and_b32_dpp v135, v172, v159 quad_perm:[1,1,1,1] row_mask:0xf bank_mask:0xf
    s_waitcnt vmcnt(18)
    buffer_load_dwordx4 v[112:115], v169, s[24:27], s32 offen offset:3072 nt
    v_mfma_f32_16x16x32_bf16 v[160:163], v[136:139], v[8:11], v[160:163]
    s_xor_b32 s32, s33, 0xf000
    s_add_u32 s34, s34, 1
    s_or_b32 s38, s34, 16
    s_add_u32 s61, s61, 1
    s_bitcmp1_b64 s[56:57], s61
    s_cbranch_scc1 L_p2_0_ev
L_p2_0_ev_back:
    v_and_b32_dpp v136, v173, v156 quad_perm:[1,1,1,1] row_mask:0xf bank_mask:0xf
    v_and_b32_dpp v137, v173, v157 quad_perm:[1,1,1,1] row_mask:0xf bank_mask:0xf
    v_and_b32_dpp v138, v173, v158 quad_perm:[1,1,1,1] row_mask:0xf bank_mask:0xf
    v_and_b32_dpp v139, v173, v159 quad_perm:[1,1,1,1] row_mask:0xf bank_mask:0xf
    s_waitcnt vmcnt(18)
    buffer_load_dwordx4 v[116:119], v169, s[24:27], s32 offen offset:0 nt
    v_mfma_f32_16x16x32_bf16 v[160:163], v[132:135], v[12:15], v[160:163]
    s_ff1_i32_b32 s38, s38
    s_mul_i32 s38, s38, 11
    s_waitcnt lgkmcnt(0)
    v_sub_f32 v174, v174, v164
    v_and_b32_dpp v132, v172, v156 quad_perm:[2,2,2,2] row_mask:0xf bank_mask:0xf
    v_and_b32_dpp v133, v172, v157 quad_perm:[2,2,2,2] row_mask:0xf bank_mask:0xf
    v_and_b32_dpp v134, v172, v158 quad_perm:[2,2,2,2] row_mask:0xf bank_mask:0xf
    v_and_b32_dpp v135, v172, v159 quad_perm:[2,2,2,2] row_mask:0xf bank_mask:0xf
    s_waitcnt vmcnt(18)
    buffer_load_dwordx4 v[120:123], v169, s[24:27], s32 offen offset:1024 nt
    v_mfma_f32_16x16x32_bf16 v[160:163], v[136:139], v[16:19], v[160:163]
    s_lshr_b64 s[38:39], s[36:37], s38
    s_and_b32 s38, s38, 0x7ff
    v_exp_f32 v174, v174
    v_and_b32_dpp v136, v173, v156 quad_perm:[2,2,2,2] row_mask:0xf bank_mask:0xf
    v_and_b32_dpp v137, v173, v157 quad_perm:[2,2,2,2] row_mask:0xf bank_mask:0xf
    v_and_b32_dpp v138, v173, v158 quad_perm:[2,2,2,2] row_mask:0xf bank_mask:0xf
    v_and_b32_dpp v139, v173, v159 quad_perm:[2,2,2,2] row_mask:0xf bank_mask:0xf
    s_waitcnt vmcnt(18)
    buffer_load_dwordx4 v[124:127], v169, s[24:27], s32 offen offset:2048 nt
    v_mfma_f32_16x16x32_bf16 v[160:163], v[132:135], v[20:23], v[160:163]
    s_lshl_b32 s38, s38, 12
    s_xor_b32 s33, s33, s38
    v_and_b32_dpp v132, v172, v156 quad_perm:[3,3,3,3] row_mask:0xf bank_mask:0xf
    v_and_b32_dpp v133, v172, v157 quad_perm:[3,3,3,3] row_mask:0xf bank_mask:0xf
    v_and_b32_dpp v134, v172, v158 quad_perm:[3,3,3,3] row_mask:0xf bank_mask:0xf
    v_and_b32_dpp v135, v172, v159 quad_perm:[3,3,3,3] row_mask:0xf bank_mask:0xf
    v_cvt_pk_bf16_f32 v172, v174, v174
    s_waitcnt vmcnt(18)
    buffer_load_dwordx4 v[128:131], v169, s[24:27], s32 offen offset:3072 nt
    v_mfma_f32_16x16x32_bf16 v[160:163], v[136:139], v[24:27], v[160:163]
    s_mov_b32 s32, s33
    s_cmp_eq_u32 s61, 64
    s_cbranch_scc1 L_tail
    v_mov_b32_dpp v172, v172 row_shr:4 row_mask:0xf bank_mask:0xa
    v_and_b32_dpp v136, v173, v156 quad_perm:[3,3,3,3] row_mask:0xf bank_mask:0xf
    v_and_b32_dpp v137, v173, v157 quad_perm:[3,3,3,3] row_mask:0xf bank_mask:0xf
    v_and_b32_dpp v138, v173, v158 quad_perm:[3,3,3,3] row_mask:0xf bank_mask:0xf
    v_and_b32_dpp v139, v173, v159 quad_perm:[3,3,3,3] row_mask:0xf bank_mask:0xf
    v_cvt_pk_bf16_f32 v173, v174, v174
    s_waitcnt vmcnt(18)
    buffer_load_dwordx4 v[4:7], v169, s[24:27], s32 offen offset:0 nt
    v_mfma_f32_16x16x32_bf16 v[160:163], v[132:135], v[28:31], v[160:163]
    v_and_b32_dpp v132, v172, v156 quad_perm:[0,0,0,0] row_mask:0xf bank_mask:0xf
    v_and_b32_dpp v133, v172, v157 quad_perm:[0,0,0,0] row_mask:0xf bank_mask:0xf
    v_and_b32_dpp v134, v172, v158 quad_perm:[0,0,0,0] row_mask:0xf bank_mask:0xf
    v_and_b32_dpp v135, v172, v159 quad_perm:[0,0,0,0] row_mask:0xf bank_mask:0xf
    v_mov_b32_dpp v173, v173 row_shl:4 row_mask:0xf bank_mask:0x5
    s_waitcnt vmcnt(18)
    buffer_load_dwordx4 v[8:11], v169, s[24:27], s32 offen offset:1024 nt
    v_mfma_f32_16x16x32_bf16 v[160:163], v[136:139], v[32:35], v[160:163]
    ds_read_b32 v174, v171 offset:512
    v_and_b32_dpp v136, v173, v156 quad_perm:[0,0,0,0] row_mask:0xf bank_mask:0xf
    v_and_b32_dpp v137, v173, v157 quad_perm:[0,0,0,0] row_mask:0xf bank_mask:0xf
    v_and_b32_dpp v138, v173, v158 quad_perm:[0,0,0,0] row_mask:0xf bank_mask:0xf
    v_and_b32_dpp v139, v173, v159 quad_perm:[0,0,0,0] row_mask:0xf bank_mask:0xf
    s_waitcnt vmcnt(18)
    buffer_load_dwordx4 v[12:15], v169, s[24:27], s32 offen offset:2048 nt
    v_mfma_f32_16x16x32_bf16 v[160:163], v[132:135], v[36:39], v[160:163]
    v_and_b32_dpp v132, v172, v156 quad_perm:[1,1,1,1] row_mask:0xf bank_mask:0xf
    v_and_b32_dpp v133, v172, v157 quad_perm:[1,1,1,1] row_mask:0xf bank_mask:0xf
    v_and_b32_dpp v134, v172, v158 quad_perm:[1,1,1,1] row_mask:0xf bank_mask:0xf
    v_and_b32_dpp v135, v172, v159 quad_perm:[1,1,1,1] row_mask:0xf bank_mask:0xf
    s_waitcnt vmcnt(18)
    buffer_load_dwordx4 v[16:19], v169, s[24:27], s32 offen offset:3072 nt
    v_mfma_f32_16x16x32_bf16 v[160:163], v[136:139], v[40:43], v[160:163]
    s_xor_b32 s32, s33, 0x8000
    v_and_b32_dpp v136, v173, v156 quad_perm:[1,1,1,1] row_mask:0xf bank_mask:0xf
    v_and_b32_dpp v137, v173, v157 quad_perm:[1,1,1,1] row_mask:0xf bank_mask:0xf
    v_and_b32_dpp v138, v173, v158 quad_perm:[1,1,1,1] row_mask:0xf bank_mask:0xf
    v_and_b32_dpp v139, v173, v159 quad_perm:[1,1,1,1] row_mask:0xf bank_mask:0xf
    s_waitcnt vmcnt(18)
    buffer_load_dwordx4 v[20:23], v169, s[24:27], s32 offen offset:0 nt
    v_mfma_f32_16x16x32_bf16 v[160:163], v[132:135], v[44:47], v[160:163]
    s_waitcnt lgkmcnt(0)
    v_sub_f32 v174, v174, v164
    v_and_b32_dpp v132, v172, v156 quad_perm:[2,2,2,2] row_mask:0xf bank_mask:0xf
    v_and_b32_dpp v133, v172, v157 quad_perm:[2,2,2,2] row_mask:0xf bank_mask:0xf
    v_and_b32_dpp v134, v172, v158 quad_perm:[2,2,2,2] row_mask:0xf bank_mask:0xf
    v_and_b32_dpp v135, v172, v159 quad_perm:[2,2,2,2] row_mask:0xf bank_mask:0xf
    s_waitcnt vmcnt(18)
    buffer_load_dwordx4 v[24:27], v169, s[24:27], s32 offen offset:1024 nt
    v_mfma_f32_16x16x32_bf16 v[160:163], v[136:139], v[48:51], v[160:163]
    v_exp_f32 v174, v174
    v_and_b32_dpp v136, v173, v156 quad_perm:[2,2,2,2] row_mask:0xf bank_mask:0xf
    v_and_b32_dpp v137, v173, v157 quad_perm:[2,2,2,2] row_mask:0xf bank_mask:0xf
    v_and_b32_dpp v138, v173, v158 quad_perm:[2,2,2,2] row_mask:0xf bank_mask:0xf
    v_and_b32_dpp v139, v173, v159 quad_perm:[2,2,2,2] row_mask:0xf bank_mask:0xf
    s_waitcnt vmcnt(18)
    buffer_load_dwordx4 v[28:31], v169, s[24:27], s32 offen offset:2048 nt
    v_mfma_f32_16x16x32_bf16 v[160:163], v[132:135], v[52:55], v[160:163]
    v_and_b32_dpp v132, v172, v156 quad_perm:[3,3,3,3] row_mask:0xf bank_mask:0xf
    v_and_b32_dpp v133, v172, v157 quad_perm:[3,3,3,3] row_mask:0xf bank_mask:0xf
    v_and_b32_dpp v134, v172, v158 quad_perm:[3,3,3,3] row_mask:0xf bank_mask:0xf
    v_and_b32_dpp v135, v172, v159 quad_perm:[3,3,3,3] row_mask:0xf bank_mask:0xf
    v_cvt_pk_bf16_f32 v172, v174, v174
    s_waitcnt vmcnt(18)
    buffer_load_dwordx4 v[32:35], v169, s[24:27], s32 offen offset:3072 nt
    v_mfma_f32_16x16x32_bf16 v[160:163], v[136:139], v[56:59], v[160:163]
    s_xor_b32 s32, s33, 0x1000
    v_mov_b32_dpp v172, v172 row_shr:4 row_mask:0xf bank_mask:0xa
    v_and_b32_dpp v136, v173, v156 quad_perm:[3,3,3,3] row_mask:0xf bank_mask:0xf
    v_and_b32_dpp v137, v173, v157 quad_perm:[3,3,3,3] row_mask:0xf bank_mask:0xf
    v_and_b32_dpp v138, v173, v158 quad_perm:[3,3,3,3] row_mask:0xf bank_mask:0xf
    v_and_b32_dpp v139, v173, v159 quad_perm:[3,3,3,3] row_mask:0xf bank_mask:0xf
    v_cvt_pk_bf16_f32 v173, v174, v174
    s_waitcnt vmcnt(18)
    buffer_load_dwordx4 v[36:39], v169, s[24:27], s32 offen offset:0 nt
    v_mfma_f32_16x16x32_bf16 v[160:163], v[132:135], v[60:63], v[160:163]
    v_and_b32_dpp v132, v172, v156 quad_perm:[0,0,0,0] row_mask:0xf bank_mask:0xf
    v_and_b32_dpp v133, v172, v157 quad_perm:[0,0,0,0] row_mask:0xf bank_mask:0xf
    v_and_b32_dpp v134, v172, v158 quad_perm:[0,0,0,0] row_mask:0xf bank_mask:0xf
    v_and_b32_dpp v135, v172, v159 quad_perm:[0,0,0,0] row_mask:0xf bank_mask:0xf
    v_mov_b32_dpp v173, v173 row_shl:4 row_mask:0xf bank_mask:0x5
    s_waitcnt vmcnt(18)
    buffer_load_dwordx4 v[40:43], v169, s[24:27], s32 offen offset:1024 nt
    v_mfma_f32_16x16x32_bf16 v[160:163], v[136:139], v[64:67], v[160:163]
    ds_read_b32 v174, v171 offset:768
    v_and_b32_dpp v136, v173, v156 quad_perm:[0,0,0,0] row_mask:0xf bank_mask:0xf
    v_and_b32_dpp v137, v173, v157 quad_perm:[0,0,0,0] row_mask:0xf bank_mask:0xf
    v_and_b32_dpp v138, v173, v158 quad_perm:[0,0,0,0] row_mask:0xf bank_mask:0xf
    v_and_b32_dpp v139, v173, v159 quad_perm:[0,0,0,0] row_mask:0xf bank_mask:0xf
    s_waitcnt vmcnt(18)
    buffer_load_dwordx4 v[44:47], v169, s[24:27], s32 offen offset:2048 nt
    v_mfma_f32_16x16x32_bf16 v[160:163], v[132:135], v[68:71], v[160:163]
    s_cmp_eq_u32 s61, 63
    s_cbranch_scc1 L_p2_0_tk
L_p2_0_tk_back:
    v_and_b32_dpp v132, v172, v156 quad_perm:[1,1,1,1] row_mask:0xf bank_mask:0xf
    v_and_b32_dpp v133, v172, v157 quad_perm:[1,1,1,1] row_mask:0xf bank_mask:0xf
    v_and_b32_dpp v134, v172, v158 quad_perm:[1,1,1,1] row_mask:0xf bank_mask:0xf
    v_and_b32_dpp v135, v172, v159 quad_perm:[1,1,1,1] row_mask:0xf bank_mask:0xf
    s_waitcnt vmcnt(18)
    buffer_load_dwordx4 v[48:51], v169, s[24:27], s32 offen offset:3072 nt
    v_mfma_f32_16x16x32_bf16 v[160:163], v[136:139], v[72:75], v[160:163]
    s_xor_b32 s32, s33, 0x9000
    v_and_b32_dpp v136, v173, v156 quad_perm:[1,1,1,1] row_mask:0xf bank_mask:0xf
    v_and_b32_dpp v137, v173, v157 quad_perm:[1,1,1,1] row_mask:0xf bank_mask:0xf
    v_and_b32_dpp v138, v173, v158 quad_perm:[1,1,1,1] row_mask:0xf bank_mask:0xf
    v_and_b32_dpp v139, v173, v159 quad_perm:[1,1,1,1] row_mask:0xf bank_mask:0xf
    s_waitcnt vmcnt(18)
    buffer_load_dwordx4 v[52:55], v169, s[24:27], s32 offen offset:0 nt
    v_mfma_f32_16x16x32_bf16 v[160:163], v[132:135], v[76:79], v[160:163]
    s_waitcnt lgkmcnt(0)
    v_sub_f32 v174, v174, v164
    v_and_b32_dpp v132, v172, v156 quad_perm:[2,2,2,2] row_mask:0xf bank_mask:0xf
    v_and_b32_dpp v133, v172, v157 quad_perm:[2,2,2,2] row_mask:0xf bank_mask:0xf
    v_and_b32_dpp v134, v172, v158 quad_perm:[2,2,2,2] row_mask:0xf bank_mask:0xf
    v_and_b32_dpp v135, v172, v159 quad_perm:[2,2,2,2] row_mask:0xf bank_mask:0xf
    s_waitcnt vmcnt(18)
    buffer_load_dwordx4 v[56:59], v169, s[24:27], s32 offen offset:1024 nt
    v_mfma_f32_16x16x32_bf16 v[160:163], v[136:139], v[80:83], v[160:163]
    v_exp_f32 v174, v174
    v_and_b32_dpp v136, v173, v156 quad_perm:[2,2,2,2] row_mask:0xf bank_mask:0xf
    v_and_b32_dpp v137, v173, v157 quad_perm:[2,2,2,2] row_mask:0xf bank_mask:0xf
    v_and_b32_dpp v138, v173, v158 quad_perm:[2,2,2,2] row_mask:0xf bank_mask:0xf
    v_and_b32_dpp v139, v173, v159 quad_perm:[2,2,2,2] row_mask:0xf bank_mask:0xf
    s_waitcnt vmcnt(18)
    buffer_load_dwordx4 v[60:63], v169, s[24:27], s32 offen offset:2048 nt
    v_mfma_f32_16x16x32_bf16 v[160:163], v[132:135], v[84:87], v[160:163]
    v_and_b32_dpp v132, v172, v156 quad_perm:[3,3,3,3] row_mask:0xf bank_mask:0xf
    v_and_b32_dpp v133, v172, v157 quad_perm:[3,3,3,3] row_mask:0xf bank_mask:0xf
    v_and_b32_dpp v134, v172, v158 quad_perm:[3,3,3,3] row_mask:0xf bank_mask:0xf
    v_and_b32_dpp v135, v172, v159 quad_perm:[3,3,3,3] row_mask:0xf bank_mask:0xf
    v_cvt_pk_bf16_f32 v172, v174, v174
    s_waitcnt vmcnt(18)
    buffer_load_dwordx4 v[64:67], v169, s[24:27], s32 offen offset:3072 nt
    v_mfma_f32_16x16x32_bf16 v[160:163], v[136:139], v[88:91], v[160:163]
    s_xor_b32 s32, s33, 0x6000
    v_mov_b32_dpp v172, v172 row_shr:4 row_mask:0xf bank_mask:0xa
    v_and_b32_dpp v136, v173, v156 quad_perm:[3,3,3,3] row_mask:0xf bank_mask:0xf
    v_and_b32_dpp v137, v173, v157 quad_perm:[3,3,3,3] row_mask:0xf bank_mask:0xf
    v_and_b32_dpp v138, v173, v158 quad_perm:[3,3,3,3] row_mask:0xf bank_mask:0xf
    v_and_b32_dpp v139, v173, v159 quad_perm:[3,3,3,3] row_mask:0xf bank_mask:0xf
    v_cvt_pk_bf16_f32 v173, v174, v174
    s_waitcnt vmcnt(18)
    buffer_load_dwordx4 v[68:71], v169, s[24:27], s32 offen offset:0 nt
    v_mfma_f32_16x16x32_bf16 v[160:163], v[132:135], v[92:95], v[160:163]
    v_and_b32_dpp v132, v172, v156 quad_perm:[0,0,0,0] row_mask:0xf bank_mask:0xf
    v_and_b32_dpp v133, v172, v157 quad_perm:[0,0,0,0] row_mask:0xf bank_mask:0xf
    v_and_b32_dpp v134, v172, v158 quad_perm:[0,0,0,0] row_mask:0xf bank_mask:0xf
    v_and_b32_dpp v135, v172, v159 quad_perm:[0,0,0,0] row_mask:0xf bank_mask:0xf
    v_mov_b32_dpp v173, v173 row_shl:4 row_mask:0xf bank_mask:0x5
    s_waitcnt vmcnt(18)
    buffer_load_dwordx4 v[72:75], v169, s[24:27], s32 offen offset:1024 nt
    v_mfma_f32_16x16x32_bf16 v[160:163], v[136:139], v[96:99], v[160:163]
    ds_read_b32 v174, v171 offset:1024
    v_and_b32_dpp v136, v173, v156 quad_perm:[0,0,0,0] row_mask:0xf bank_mask:0xf
    v_and_b32_dpp v137, v173, v157 quad_perm:[0,0,0,0] row_mask:0xf bank_mask:0xf
    v_and_b32_dpp v138, v173, v158 quad_perm:[0,0,0,0] row_mask:0xf bank_mask:0xf
    v_and_b32_dpp v139, v173, v159 quad_perm:[0,0,0,0] row_mask:0xf bank_mask:0xf
    s_waitcnt vmcnt(18)
    buffer_load_dwordx4 v[76:79], v169, s[24:27], s32 offen offset:2048 nt
    v_mfma_f32_16x16x32_bf16 v[160:163], v[132:135], v[100:103], v[160:163]
    v_and_b32_dpp v132, v172, v156 quad_perm:[1,1,1,1] row_mask:0xf bank_mask:0xf
    v_and_b32_dpp v133, v172, v157 quad_perm:[1,1,1,1] row_mask:0xf bank_mask:0xf
    v_and_b32_dpp v134, v172, v158 quad_perm:[1,1,1,1] row_mask:0xf bank_mask:0xf
    v_and_b32_dpp v135, v172, v159 quad_perm:[1,1,1,1] row_mask:0xf bank_mask:0xf
    s_waitcnt vmcnt(18)
    buffer_load_dwordx4 v[80:83], v169, s[24:27], s32 offen offset:3072 nt
    v_mfma_f32_16x16x32_bf16 v[160:163], v[136:139], v[104:107], v[160:163]
    s_xor_b32 s32, s33, 0xe000
    v_and_b32_dpp v136, v173, v156 quad_perm:[1,1,1,1] row_mask:0xf bank_mask:0xf
    v_and_b32_dpp v137, v173, v157 quad_perm:[1,1,1,1] row_mask:0xf bank_mask:0xf
    v_and_b32_dpp v138, v173, v158 quad_perm:[1,1,1,1] row_mask:0xf bank_mask:0xf
    v_and_b32_dpp v139, v173, v159 quad_perm:[1,1,1,1] row_mask:0xf bank_mask:0xf
    s_waitcnt vmcnt(18)
    buffer_load_dwordx4 v[84:87], v169, s[24:27], s32 offen offset:0 nt
    v_mfma_f32_16x16x32_bf16 v[160:163], v[132:135], v[108:111], v[160:163]
    s_waitcnt lgkmcnt(0)
    v_sub_f32 v174, v174, v164
    v_and_b32_dpp v132, v172, v156 quad_perm:[2,2,2,2] row_mask:0xf bank_mask:0xf
    v_and_b32_dpp v133, v172, v157 quad_perm:[2,2,2,2] row_mask:0xf bank_mask:0xf
    v_and_b32_dpp v134, v172, v158 quad_perm:[2,2,2,2] row_mask:0xf bank_mask:0xf
    v_and_b32_dpp v135, v172, v159 quad_perm:[2,2,2,2] row_mask:0xf bank_mask:0xf
    s_waitcnt vmcnt(18)
    buffer_load_dwordx4 v[88:91], v169, s[24:27], s32 offen offset:1024 nt
    v_mfma_f32_16x16x32_bf16 v[160:163], v[136:139], v[112:115], v[160:163]
    ds_read_b32 v175, v176 offset:34304
    v_exp_f32 v174, v174
    v_and_b32_dpp v136, v173, v156 quad_perm:[2,2,2,2] row_mask:0xf bank_mask:0xf
    v_and_b32_dpp v137, v173, v157 quad_perm:[2,2,2,2] row_mask:0xf bank_mask:0xf
    v_and_b32_dpp v138, v173, v158 quad_perm:[2,2,2,2] row_mask:0xf bank_mask:0xf
    v_and_b32_dpp v139, v173, v159 quad_perm:[2,2,2,2] row_mask:0xf bank_mask:0xf
    s_waitcnt vmcnt(18)
    buffer_load_dwordx4 v[92:95], v169, s[24:27], s32 offen offset:2048 nt
    v_mfma_f32_16x16x32_bf16 v[160:163], v[132:135], v[116:119], v[160:163]
    v_add_u32 v171, 1024, v171
    v_and_b32_dpp v132, v172, v156 quad_perm:[3,3,3,3] row_mask:0xf bank_mask:0xf
    v_and_b32_dpp v133, v172, v157 quad_perm:[3,3,3,3] row_mask:0xf bank_mask:0xf
    v_and_b32_dpp v134, v172, v158 quad_perm:[3,3,3,3] row_mask:0xf bank_mask:0xf
    v_and_b32_dpp v135, v172, v159 quad_perm:[3,3,3,3] row_mask:0xf bank_mask:0xf
    v_cvt_pk_bf16_f32 v172, v174, v174
    s_waitcnt vmcnt(18)
    buffer_load_dwordx4 v[96:99], v169, s[24:27], s32 offen offset:3072 nt
    v_mfma_f32_16x16x32_bf16 v[160:163], v[136:139], v[120:123], v[160:163]
    s_xor_b32 s32, s33, 0x7000
    s_waitcnt lgkmcnt(0)
    v_readfirstlane_b32 s60, v175
    v_mov_b32_dpp v172, v172 row_shr:4 row_mask:0xf bank_mask:0xa
    v_and_b32_dpp v136, v173, v156 quad_perm:[3,3,3,3] row_mask:0xf bank_mask:0xf
    v_and_b32_dpp v137, v173, v157 quad_perm:[3,3,3,3] row_mask:0xf bank_mask:0xf
    v_and_b32_dpp v138, v173, v158 quad_perm:[3,3,3,3] row_mask:0xf bank_mask:0xf
    v_and_b32_dpp v139, v173, v159 quad_perm:[3,3,3,3] row_mask:0xf bank_mask:0xf
    v_cvt_pk_bf16_f32 v173, v174, v174
    s_waitcnt vmcnt(18)
    buffer_load_dwordx4 v[100:103], v169, s[24:27], s32 offen offset:0 nt
    v_mfma_f32_16x16x32_bf16 v[160:163], v[132:135], v[124:127], v[160:163]
    s_lshr_b32 s22, s60, 2
    s_and_b32 s60, s60, 3
    s_cmp_ge_u32 s61, s22
    s_cselect_b32 s60, 1, s60
    s_cmp_ge_u32 s61, 62
    s_cselect_b32 s60, 2, s60
    v_and_b32_dpp v132, v172, v156 quad_perm:[0,0,0,0] row_mask:0xf bank_mask:0xf
    v_and_b32_dpp v133, v172, v157 quad_perm:[0,0,0,0] row_mask:0xf bank_mask:0xf
    v_and_b32_dpp v134, v172, v158 quad_perm:[0,0,0,0] row_mask:0xf bank_mask:0xf
    v_and_b32_dpp v135, v172, v159 quad_perm:[0,0,0,0] row_mask:0xf bank_mask:0xf
    v_mov_b32_dpp v173, v173 row_shl:4 row_mask:0xf bank_mask:0x5
    s_waitcnt vmcnt(18)
    buffer_load_dwordx4 v[104:107], v169, s[24:27], s32 offen offset:1024 nt
    v_mfma_f32_16x16x32_bf16 v[160:163], v[136:139], v[128:131], v[160:163]
    s_cmp_eq_u32 s60, 0
    s_cbranch_scc1 L_p2_0
    s_cmp_eq_u32 s60, 1
    s_cbranch_scc1 L_p2_1
    s_branch L_p2_2
L_p2_1:
    ds_read_b32 v174, v171 offset:256
    v_and_b32_dpp v136, v173, v156 quad_perm:[0,0,0,0] row_mask:0xf bank_mask:0xf
    v_and_b32_dpp v137, v173, v157 quad_perm:[0,0,0,0] row_mask:0xf bank_mask:0xf
    v_and_b32_dpp v138, v173, v158 quad_perm:[0,0,0,0] row_mask:0xf bank_mask:0xf
    v_and_b32_dpp v139, v173, v159 quad_perm:[0,0,0,0] row_mask:0xf bank_mask:0xf
    s_waitcnt vmcnt(19)
    buffer_load_dwordx4 v[108:111], v169, s[24:27], s32 offen offset:2048 nt
    v_mfma_f32_16x16x32_bf16 v[160:163], v[132:135], v[4:7], v[160:163]
    v_and_b32_dpp v132, v172, v156 quad_perm:[1,1,1,1] row_mask:0xf bank_mask:0xf
    v_and_b32_dpp v133, v172, v157 quad_perm:[1,1,1,1] row_mask:0xf bank_mask:0xf
    v_and_b32_dpp v134, v172, v158 quad_perm:[1,1,1,1] row_mask:0xf bank_mask:0xf
    v_and_b32_dpp v135, v172, v159 quad_perm:[1,1,1,1] row_mask:0xf bank_mask:0xf
    s_waitcnt vmcnt(19)
    buffer_load_dwordx4 v[112:115], v169, s[24:27], s32 offen offset:3072 nt
    v_mfma_f32_16x16x32_bf16 v[160:163], v[136:139], v[8:11], v[160:163]
    s_xor_b32 s32, s33, 0xf000
    s_add_u32 s34, s34, 1
    s_or_b32 s38, s34, 16
    s_add_u32 s61, s61, 1
    s_bitcmp1_b64 s[56:57], s61
    s_cbranch_scc1 L_p2_1_ev
L_p2_1_ev_back:
    v_and_b32_dpp v136, v173, v156 quad_perm:[1,1,1,1] row_mask:0xf bank_mask:0xf
    v_and_b32_dpp v137, v173, v157 quad_perm:[1,1,1,1] row_mask:0xf bank_mask:0xf
    v_and_b32_dpp v138, v173, v158 quad_perm:[1,1,1,1] row_mask:0xf bank_mask:0xf
    v_and_b32_dpp v139, v173, v159 quad_perm:[1,1,1,1] row_mask:0xf bank_mask:0xf
    s_waitcnt vmcnt(19)
    buffer_load_dwordx4 v[116:119], v169, s[24:27], s32 offen offset:0 nt
    v_mfma_f32_16x16x32_bf16 v[160:163], v[132:135], v[12:15], v[160:163]
    s_ff1_i32_b32 s38, s38
    s_mul_i32 s38, s38, 11
    s_waitcnt lgkmcnt(0)
    v_sub_f32 v174, v174, v164
    v_and_b32_dpp v132, v172, v156 quad_perm:[2,2,2,2] row_mask:0xf bank_mask:0xf
    v_and_b32_dpp v133, v172, v157 quad_perm:[2,2,2,2] row_mask:0xf bank_mask:0xf
    v_and_b32_dpp v134, v172, v158 quad_perm:[2,2,2,2] row_mask:0xf bank_mask:0xf
    v_and_b32_dpp v135, v172, v159 quad_perm:[2,2,2,2] row_mask:0xf bank_mask:0xf
    s_waitcnt vmcnt(19)
    buffer_load_dwordx4 v[120:123], v169, s[24:27], s32 offen offset:1024 nt
    v_mfma_f32_16x16x32_bf16 v[160:163], v[136:139], v[16:19], v[160:163]
    s_lshr_b64 s[38:39], s[36:37], s38
    s_and_b32 s38, s38, 0x7ff
    v_exp_f32 v174, v174
    v_and_b32_dpp v136, v173, v156 quad_perm:[2,2,2,2] row_mask:0xf bank_mask:0xf
    v_and_b32_dpp v137, v173, v157 quad_perm:[2,2,2,2] row_mask:0xf bank_mask:0xf
    v_and_b32_dpp v138, v173, v158 quad_perm:[2,2,2,2] row_mask:0xf bank_mask:0xf
    v_and_b32_dpp v139, v173, v159 quad_perm:[2,2,2,2] row_mask:0xf bank_mask:0xf
    s_waitcnt vmcnt(19)
    buffer_load_dwordx4 v[124:127], v169, s[24:27], s32 offen offset:2048 nt
    v_mfma_f32_16x16x32_bf16 v[160:163], v[132:135], v[20:23], v[160:163]
    s_lshl_b32 s38, s38, 12
    s_xor_b32 s33, s33, s38
    v_and_b32_dpp v132, v172, v156 quad_perm:[3,3,3,3] row_mask:0xf bank_mask:0xf
    v_and_b32_dpp v133, v172, v157 quad_perm:[3,3,3,3] row_mask:0xf bank_mask:0xf
    v_and_b32_dpp v134, v172, v158 quad_perm:[3,3,3,3] row_mask:0xf bank_mask:0xf
    v_and_b32_dpp v135, v172, v159 quad_perm:[3,3,3,3] row_mask:0xf bank_mask:0xf
    v_cvt_pk_bf16_f32 v172, v174, v174
    s_waitcnt vmcnt(19)
    buffer_load_dwordx4 v[128:131], v169, s[24:27], s32 offen offset:3072 nt
    v_mfma_f32_16x16x32_bf16 v[160:163], v[136:139], v[24:27], v[160:163]
    s_mov_b32 s32, s33
    s_cmp_eq_u32 s61, 64
    s_cbranch_scc1 L_tail
    v_mov_b32_dpp v172, v172 row_shr:4 row_mask:0xf bank_mask:0xa
    v_and_b32_dpp v136, v173, v156 quad_perm:[3,3,3,3] row_mask:0xf bank_mask:0xf
    v_and_b32_dpp v137, v173, v157 quad_perm:[3,3,3,3] row_mask:0xf bank_mask:0xf
    v_and_b32_dpp v138, v173, v158 quad_perm:[3,3,3,3] row_mask:0xf bank_mask:0xf
    v_and_b32_dpp v139, v173, v159 quad_perm:[3,3,3,3] row_mask:0xf bank_mask:0xf
    v_cvt_pk_bf16_f32 v173, v174, v174
    s_waitcnt vmcnt(19)
    buffer_load_dwordx4 v[4:7], v169, s[24:27], s32 offen offset:0 nt
    v_mfma_f32_16x16x32_bf16 v[160:163], v[132:135], v[28:31], v[160:163]
    v_and_b32_dpp v132, v172, v156 quad_perm:[0,0,0,0] row_mask:0xf bank_mask:0xf
    v_and_b32_dpp v133, v172, v157 quad_perm:[0,0,0,0] row_mask:0xf bank_mask:0xf
    v_and_b32_dpp v134, v172, v158 quad_perm:[0,0,0,0] row_mask:0xf bank_mask:0xf
    v_and_b32_dpp v135, v172, v159 quad_perm:[0,0,0,0] row_mask:0xf bank_mask:0xf
    v_mov_b32_dpp v173, v173 row_shl:4 row_mask:0xf bank_mask:0x5
    s_waitcnt vmcnt(19)
    buffer_load_dwordx4 v[8:11], v169, s[24:27], s32 offen offset:1024 nt
    v_mfma_f32_16x16x32_bf16 v[160:163], v[136:139], v[32:35], v[160:163]
    ds_read_b32 v174, v171 offset:512
    v_and_b32_dpp v136, v173, v156 quad_perm:[0,0,0,0] row_mask:0xf bank_mask:0xf
    v_and_b32_dpp v137, v173, v157 quad_perm:[0,0,0,0] row_mask:0xf bank_mask:0xf
    v_and_b32_dpp v138, v173, v158 quad_perm:[0,0,0,0] row_mask:0xf bank_mask:0xf
    v_and_b32_dpp v139, v173, v159 quad_perm:[0,0,0,0] row_mask:0xf bank_mask:0xf
    s_waitcnt vmcnt(19)
    buffer_load_dwordx4 v[12:15], v169, s[24:27], s32 offen offset:2048 nt
    v_mfma_f32_16x16x32_bf16 v[160:163], v[132:135], v[36:39], v[160:163]
    v_and_b32_dpp v132, v172, v156 quad_perm:[1,1,1,1] row_mask:0xf bank_mask:0xf
    v_and_b32_dpp v133, v172, v157 quad_perm:[1,1,1,1] row_mask:0xf bank_mask:0xf
    v_and_b32_dpp v134, v172, v158 quad_perm:[1,1,1,1] row_mask:0xf bank_mask:0xf
    v_and_b32_dpp v135, v172, v159 quad_perm:[1,1,1,1] row_mask:0xf bank_mask:0xf
    s_waitcnt vmcnt(19)
    buffer_load_dwordx4 v[16:19], v169, s[24:27], s32 offen offset:3072 nt
    v_mfma_f32_16x16x32_bf16 v[160:163], v[136:139], v[40:43], v[160:163]
    s_xor_b32 s32, s33, 0x8000
    v_and_b32_dpp v136, v173, v156 quad_perm:[1,1,1,1] row_mask:0xf bank_mask:0xf
    v_and_b32_dpp v137, v173, v157 quad_perm:[1,1,1,1] row_mask:0xf bank_mask:0xf
    v_and_b32_dpp v138, v173, v158 quad_perm:[1,1,1,1] row_mask:0xf bank_mask:0xf
    v_and_b32_dpp v139, v173, v159 quad_perm:[1,1,1,1] row_mask:0xf bank_mask:0xf
    s_waitcnt vmcnt(19)
    buffer_load_dwordx4 v[20:23], v169, s[24:27], s32 offen offset:0 nt
    v_mfma_f32_16x16x32_bf16 v[160:163], v[132:135], v[44:47], v[160:163]
    s_waitcnt lgkmcnt(0)
    v_sub_f32 v174, v174, v164
    v_and_b32_dpp v132, v172, v156 quad_perm:[2,2,2,2] row_mask:0xf bank_mask:0xf
    v_and_b32_dpp v133, v172, v157 quad_perm:[2,2,2,2] row_mask:0xf bank_mask:0xf
    v_and_b32_dpp v134, v172, v158 quad_perm:[2,2,2,2] row_mask:0xf bank_mask:0xf
    v_and_b32_dpp v135, v172, v159 quad_perm:[2,2,2,2] row_mask:0xf bank_mask:0xf
    s_waitcnt vmcnt(19)
    buffer_load_dwordx4 v[24:27], v169, s[24:27], s32 offen offset:1024 nt
    v_mfma_f32_16x16x32_bf16 v[160:163], v[136:139], v[48:51], v[160:163]
    v_exp_f32 v174, v174
    v_and_b32_dpp v136, v173, v156 quad_perm:[2,2,2,2] row_mask:0xf bank_mask:0xf
    v_and_b32_dpp v137, v173, v157 quad_perm:[2,2,2,2] row_mask:0xf bank_mask:0xf
    v_and_b32_dpp v138, v173, v158 quad_perm:[2,2,2,2] row_mask:0xf bank_mask:0xf
    v_and_b32_dpp v139, v173, v159 quad_perm:[2,2,2,2] row_mask:0xf bank_mask:0xf
    s_waitcnt vmcnt(19)
    buffer_load_dwordx4 v[28:31], v169, s[24:27], s32 offen offset:2048 nt
    v_mfma_f32_16x16x32_bf16 v[160:163], v[132:135], v[52:55], v[160:163]
    v_and_b32_dpp v132, v172, v156 quad_perm:[3,3,3,3] row_mask:0xf bank_mask:0xf
    v_and_b32_dpp v133, v172, v157 quad_perm:[3,3,3,3] row_mask:0xf bank_mask:0xf
    v_and_b32_dpp v134, v172, v158 quad_perm:[3,3,3,3] row_mask:0xf bank_mask:0xf
    v_and_b32_dpp v135, v172, v159 quad_perm:[3,3,3,3] row_mask:0xf bank_mask:0xf
    v_cvt_pk_bf16_f32 v172, v174, v174
    s_waitcnt vmcnt(19)
    buffer_load_dwordx4 v[32:35], v169, s[24:27], s32 offen offset:3072 nt
    v_mfma_f32_16x16x32_bf16 v[160:163], v[136:139], v[56:59], v[160:163]
    s_xor_b32 s32, s33, 0x1000
    v_mov_b32_dpp v172, v172 row_shr:4 row_mask:0xf bank_mask:0xa
    v_and_b32_dpp v136, v173, v156 quad_perm:[3,3,3,3] row_mask:0xf bank_mask:0xf
    v_and_b32_dpp v137, v173, v157 quad_perm:[3,3,3,3] row_mask:0xf bank_mask:0xf
    v_and_b32_dpp v138, v173, v158 quad_perm:[3,3,3,3] row_mask:0xf bank_mask:0xf
    v_and_b32_dpp v139, v173, v159 quad_perm:[3,3,3,3] row_mask:0xf bank_mask:0xf
    v_cvt_pk_bf16_f32 v173, v174, v174
    s_waitcnt vmcnt(19)
    buffer_load_dwordx4 v[36:39], v169, s[24:27], s32 offen offset:0 nt
    v_mfma_f32_16x16x32_bf16 v[160:163], v[132:135], v[60:63], v[160:163]
    v_and_b32_dpp v132, v172, v156 quad_perm:[0,0,0,0] row_mask:0xf bank_mask:0xf
    v_and_b32_dpp v133, v172, v157 quad_perm:[0,0,0,0] row_mask:0xf bank_mask:0xf
    v_and_b32_dpp v134, v172, v158 quad_perm:[0,0,0,0] row_mask:0xf bank_mask:0xf
    v_and_b32_dpp v135, v172, v159 quad_perm:[0,0,0,0] row_mask:0xf bank_mask:0xf
    v_mov_b32_dpp v173, v173 row_shl:4 row_mask:0xf bank_mask:0x5
    s_waitcnt vmcnt(19)
    buffer_load_dwordx4 v[40:43], v169, s[24:27], s32 offen offset:1024 nt
    v_mfma_f32_16x16x32_bf16 v[160:163], v[136:139], v[64:67], v[160:163]
    ds_read_b32 v174, v171 offset:768
    v_and_b32_dpp v136, v173, v156 quad_perm:[0,0,0,0] row_mask:0xf bank_mask:0xf
    v_and_b32_dpp v137, v173, v157 quad_perm:[0,0,0,0] row_mask:0xf bank_mask:0xf
    v_and_b32_dpp v138, v173, v158 quad_perm:[0,0,0,0] row_mask:0xf bank_mask:0xf
    v_and_b32_dpp v139, v173, v159 quad_perm:[0,0,0,0] row_mask:0xf bank_mask:0xf
    s_waitcnt vmcnt(19)
    buffer_load_dwordx4 v[44:47], v169, s[24:27], s32 offen offset:2048 nt
    v_mfma_f32_16x16x32_bf16 v[160:163], v[132:135], v[68:71], v[160:163]
    s_cmp_eq_u32 s61, 63
    s_cbranch_scc1 L_p2_1_tk
L_p2_1_tk_back:
    v_and_b32_dpp v132, v172, v156 quad_perm:[1,1,1,1] row_mask:0xf bank_mask:0xf
    v_and_b32_dpp v133, v172, v157 quad_perm:[1,1,1,1] row_mask:0xf bank_mask:0xf
    v_and_b32_dpp v134, v172, v158 quad_perm:[1,1,1,1] row_mask:0xf bank_mask:0xf
    v_and_b32_dpp v135, v172, v159 quad_perm:[1,1,1,1] row_mask:0xf bank_mask:0xf
    s_waitcnt vmcnt(19)
    buffer_load_dwordx4 v[48:51], v169, s[24:27], s32 offen offset:3072 nt
    v_mfma_f32_16x16x32_bf16 v[160:163], v[136:139], v[72:75], v[160:163]
    s_xor_b32 s32, s33, 0x9000
    v_and_b32_dpp v136, v173, v156 quad_perm:[1,1,1,1] row_mask:0xf bank_mask:0xf
    v_and_b32_dpp v137, v173, v157 quad_perm:[1,1,1,1] row_mask:0xf bank_mask:0xf
    v_and_b32_dpp v138, v173, v158 quad_perm:[1,1,1,1] row_mask:0xf bank_mask:0xf
    v_and_b32_dpp v139, v173, v159 quad_perm:[1,1,1,1] row_mask:0xf bank_mask:0xf
    s_waitcnt vmcnt(19)
    buffer_load_dwordx4 v[52:55], v169, s[24:27], s32 offen offset:0 nt
    v_mfma_f32_16x16x32_bf16 v[160:163], v[132:135], v[76:79], v[160:163]
    s_waitcnt lgkmcnt(0)
    v_sub_f32 v174, v174, v164
    v_and_b32_dpp v132, v172, v156 quad_perm:[2,2,2,2] row_mask:0xf bank_mask:0xf
    v_and_b32_dpp v133, v172, v157 quad_perm:[2,2,2,2] row_mask:0xf bank_mask:0xf
    v_and_b32_dpp v134, v172, v158 quad_perm:[2,2,2,2] row_mask:0xf bank_mask:0xf
    v_and_b32_dpp v135, v172, v159 quad_perm:[2,2,2,2] row_mask:0xf bank_mask:0xf
    s_waitcnt vmcnt(19)
    buffer_load_dwordx4 v[56:59], v169, s[24:27], s32 offen offset:1024 nt
    v_mfma_f32_16x16x32_bf16 v[160:163], v[136:139], v[80:83], v[160:163]
    v_exp_f32 v174, v174
    v_and_b32_dpp v136, v173, v156 quad_perm:[2,2,2,2] row_mask:0xf bank_mask:0xf
    v_and_b32_dpp v137, v173, v157 quad_perm:[2,2,2,2] row_mask:0xf bank_mask:0xf
    v_and_b32_dpp v138, v173, v158 quad_perm:[2,2,2,2] row_mask:0xf bank_mask:0xf
    v_and_b32_dpp v139, v173, v159 quad_perm:[2,2,2,2] row_mask:0xf bank_mask:0xf
    s_waitcnt vmcnt(19)
    buffer_load_dwordx4 v[60:63], v169, s[24:27], s32 offen offset:2048 nt
    v_mfma_f32_16x16x32_bf16 v[160:163], v[132:135], v[84:87], v[160:163]
    v_and_b32_dpp v132, v172, v156 quad_perm:[3,3,3,3] row_mask:0xf bank_mask:0xf
    v_and_b32_dpp v133, v172, v157 quad_perm:[3,3,3,3] row_mask:0xf bank_mask:0xf
    v_and_b32_dpp v134, v172, v158 quad_perm:[3,3,3,3] row_mask:0xf bank_mask:0xf
    v_and_b32_dpp v135, v172, v159 quad_perm:[3,3,3,3] row_mask:0xf bank_mask:0xf
    v_cvt_pk_bf16_f32 v172, v174, v174
    s_waitcnt vmcnt(19)
    buffer_load_dwordx4 v[64:67], v169, s[24:27], s32 offen offset:3072 nt
    v_mfma_f32_16x16x32_bf16 v[160:163], v[136:139], v[88:91], v[160:163]
    s_xor_b32 s32, s33, 0x6000
    v_mov_b32_dpp v172, v172 row_shr:4 row_mask:0xf bank_mask:0xa
    v_and_b32_dpp v136, v173, v156 quad_perm:[3,3,3,3] row_mask:0xf bank_mask:0xf
    v_and_b32_dpp v137, v173, v157 quad_perm:[3,3,3,3] row_mask:0xf bank_mask:0xf
    v_and_b32_dpp v138, v173, v158 quad_perm:[3,3,3,3] row_mask:0xf bank_mask:0xf
    v_and_b32_dpp v139, v173, v159 quad_perm:[3,3,3,3] row_mask:0xf bank_mask:0xf
    v_cvt_pk_bf16_f32 v173, v174, v174
    s_waitcnt vmcnt(19)
    buffer_load_dwordx4 v[68:71], v169, s[24:27], s32 offen offset:0 nt
    v_mfma_f32_16x16x32_bf16 v[160:163], v[132:135], v[92:95], v[160:163]
    v_and_b32_dpp v132, v172, v156 quad_perm:[0,0,0,0] row_mask:0xf bank_mask:0xf
    v_and_b32_dpp v133, v172, v157 quad_perm:[0,0,0,0] row_mask:0xf bank_mask:0xf
    v_and_b32_dpp v134, v172, v158 quad_perm:[0,0,0,0] row_mask:0xf bank_mask:0xf
    v_and_b32_dpp v135, v172, v159 quad_perm:[0,0,0,0] row_mask:0xf bank_mask:0xf
    v_mov_b32_dpp v173, v173 row_shl:4 row_mask:0xf bank_mask:0x5
    s_waitcnt vmcnt(19)
    buffer_load_dwordx4 v[72:75], v169, s[24:27], s32 offen offset:1024 nt
    v_mfma_f32_16x16x32_bf16 v[160:163], v[136:139], v[96:99], v[160:163]
    ds_read_b32 v174, v171 offset:1024
    v_and_b32_dpp v136, v173, v156 quad_perm:[0,0,0,0] row_mask:0xf bank_mask:0xf
    v_and_b32_dpp v137, v173, v157 quad_perm:[0,0,0,0] row_mask:0xf bank_mask:0xf
    v_and_b32_dpp v138, v173, v158 quad_perm:[0,0,0,0] row_mask:0xf bank_mask:0xf
    v_and_b32_dpp v139, v173, v159 quad_perm:[0,0,0,0] row_mask:0xf bank_mask:0xf
    s_waitcnt vmcnt(19)
    buffer_load_dwordx4 v[76:79], v169, s[24:27], s32 offen offset:2048 nt
    v_mfma_f32_16x16x32_bf16 v[160:163], v[132:135], v[100:103], v[160:163]
    v_and_b32_dpp v132, v172, v156 quad_perm:[1,1,1,1] row_mask:0xf bank_mask:0xf
    v_and_b32_dpp v133, v172, v157 quad_perm:[1,1,1,1] row_mask:0xf bank_mask:0xf
    v_and_b32_dpp v134, v172, v158 quad_perm:[1,1,1,1] row_mask:0xf bank_mask:0xf
    v_and_b32_dpp v135, v172, v159 quad_perm:[1,1,1,1] row_mask:0xf bank_mask:0xf
    s_waitcnt vmcnt(19)
    buffer_load_dwordx4 v[80:83], v169, s[24:27], s32 offen offset:3072 nt
    v_mfma_f32_16x16x32_bf16 v[160:163], v[136:139], v[104:107], v[160:163]
    s_xor_b32 s32, s33, 0xe000
    v_and_b32_dpp v136, v173, v156 quad_perm:[1,1,1,1] row_mask:0xf bank_mask:0xf
    v_and_b32_dpp v137, v173, v157 quad_perm:[1,1,1,1] row_mask:0xf bank_mask:0xf
    v_and_b32_dpp v138, v173, v158 quad_perm:[1,1,1,1] row_mask:0xf bank_mask:0xf
    v_and_b32_dpp v139, v173, v159 quad_perm:[1,1,1,1] row_mask:0xf bank_mask:0xf
    s_waitcnt vmcnt(19)
    buffer_load_dwordx4 v[84:87], v169, s[24:27], s32 offen offset:0 nt
    v_mfma_f32_16x16x32_bf16 v[160:163], v[132:135], v[108:111], v[160:163]
    s_waitcnt lgkmcnt(0)
    v_sub_f32 v174, v174, v164
    v_and_b32_dpp v132, v172, v156 quad_perm:[2,2,2,2] row_mask:0xf bank_mask:0xf
    v_and_b32_dpp v133, v172, v157 quad_perm:[2,2,2,2] row_mask:0xf bank_mask:0xf
    v_and_b32_dpp v134, v172, v158 quad_perm:[2,2,2,2] row_mask:0xf bank_mask:0xf
    v_and_b32_dpp v135, v172, v159 quad_perm:[2,2,2,2] row_mask:0xf bank_mask:0xf
    s_waitcnt vmcnt(19)
    buffer_load_dwordx4 v[88:91], v169, s[24:27], s32 offen offset:1024 nt
    v_mfma_f32_16x16x32_bf16 v[160:163], v[136:139], v[112:115], v[160:163]
    ds_read_b32 v175, v176 offset:34304
    v_exp_f32 v174, v174
    v_and_b32_dpp v136, v173, v156 quad_perm:[2,2,2,2] row_mask:0xf bank_mask:0xf
    v_and_b32_dpp v137, v173, v157 quad_perm:[2,2,2,2] row_mask:0xf bank_mask:0xf
    v_and_b32_dpp v138, v173, v158 quad_perm:[2,2,2,2] row_mask:0xf bank_mask:0xf
    v_and_b32_dpp v139, v173, v159 quad_perm:[2,2,2,2] row_mask:0xf bank_mask:0xf
    s_waitcnt vmcnt(19)
    buffer_load_dwordx4 v[92:95], v169, s[24:27], s32 offen offset:2048 nt
    v_mfma_f32_16x16x32_bf16 v[160:163], v[132:135], v[116:119], v[160:163]
    v_add_u32 v171, 1024, v171
    v_and_b32_dpp v132, v172, v156 quad_perm:[3,3,3,3] row_mask:0xf bank_mask:0xf
    v_and_b32_dpp v133, v172, v157 quad_perm:[3,3,3,3] row_mask:0xf bank_mask:0xf
    v_and_b32_dpp v134, v172, v158 quad_perm:[3,3,3,3] row_mask:0xf bank_mask:0xf
    v_and_b32_dpp v135, v172, v159 quad_perm:[3,3,3,3] row_mask:0xf bank_mask:0xf
    v_cvt_pk_bf16_f32 v172, v174, v174
    s_waitcnt vmcnt(19)
    buffer_load_dwordx4 v[96:99], v169, s[24:27], s32 offen offset:3072 nt
    v_mfma_f32_16x16x32_bf16 v[160:163], v[136:139], v[120:123], v[160:163]
    s_xor_b32 s32, s33, 0x7000
    s_waitcnt lgkmcnt(0)
    v_readfirstlane_b32 s60, v175
    v_mov_b32_dpp v172, v172 row_shr:4 row_mask:0xf bank_mask:0xa
    v_and_b32_dpp v136, v173, v156 quad_perm:[3,3,3,3] row_mask:0xf bank_mask:0xf
    v_and_b32_dpp v137, v173, v157 quad_perm:[3,3,3,3] row_mask:0xf bank_mask:0xf
    v_and_b32_dpp v138, v173, v158 quad_perm:[3,3,3,3] row_mask:0xf bank_mask:0xf
    v_and_b32_dpp v139, v173, v159 quad_perm:[3,3,3,3] row_mask:0xf bank_mask:0xf
    v_cvt_pk_bf16_f32 v173, v174, v174
    s_waitcnt vmcnt(19)
    buffer_load_dwordx4 v[100:103], v169, s[24:27], s32 offen offset:0 nt
    v_mfma_f32_16x16x32_bf16 v[160:163], v[132:135], v[124:127], v[160:163]
    s_lshr_b32 s22, s60, 2
    s_and_b32 s60, s60, 3
    s_cmp_ge_u32 s61, s22
    s_cselect_b32 s60, 1, s60
    s_cmp_ge_u32 s61, 62
    s_cselect_b32 s60, 2, s60
    v_and_b32_dpp v132, v172, v156 quad_perm:[0,0,0,0] row_mask:0xf bank_mask:0xf
    v_and_b32_dpp v133, v172, v157 quad_perm:[0,0,0,0] row_mask:0xf bank_mask:0xf
    v_and_b32_dpp v134, v172, v158 quad_perm:[0,0,0,0] row_mask:0xf bank_mask:0xf
    v_and_b32_dpp v135, v172, v159 quad_perm:[0,0,0,0] row_mask:0xf bank_mask:0xf
    v_mov_b32_dpp v173, v173 row_shl:4 row_mask:0xf bank_mask:0x5
    s_waitcnt vmcnt(19)
    buffer_load_dwordx4 v[104:107], v169, s[24:27], s32 offen offset:1024 nt
    v_mfma_f32_16x16x32_bf16 v[160:163], v[136:139], v[128:131], v[160:163]
    s_cmp_eq_u32 s60, 1
    s_cbranch_scc1 L_p2_1
    s_cmp_eq_u32 s60, 0
    s_cbranch_scc1 L_p2_0
    s_branch L_p2_2
L_p2_2:
    ds_read_b32 v174, v171 offset:256
    v_and_b32_dpp v136, v173, v156 quad_perm:[0,0,0,0] row_mask:0xf bank_mask:0xf
    v_and_b32_dpp v137, v173, v157 quad_perm:[0,0,0,0] row_mask:0xf bank_mask:0xf
    v_and_b32_dpp v138, v173, v158 quad_perm:[0,0,0,0] row_mask:0xf bank_mask:0xf
    v_and_b32_dpp v139, v173, v159 quad_perm:[0,0,0,0] row_mask:0xf bank_mask:0xf
    s_waitcnt vmcnt(22)
    buffer_load_dwordx4 v[108:111], v169, s[24:27], s32 offen offset:2048 nt
    v_mfma_f32_16x16x32_bf16 v[160:163], v[132:135], v[4:7], v[160:163]
    v_and_b32_dpp v132, v172, v156 quad_perm:[1,1,1,1] row_mask:0xf bank_mask:0xf
    v_and_b32_dpp v133, v172, v157 quad_perm:[1,1,1,1] row_mask:0xf bank_mask:0xf
    v_and_b32_dpp v134, v172, v158 quad_perm:[1,1,1,1] row_mask:0xf bank_mask:0xf
    v_and_b32_dpp v135, v172, v159 quad_perm:[1,1,1,1] row_mask:0xf bank_mask:0xf
    s_waitcnt vmcnt(22)
    buffer_load_dwordx4 v[112:115], v169, s[24:27], s32 offen offset:3072 nt
    v_mfma_f32_16x16x32_bf16 v[160:163], v[136:139], v[8:11], v[160:163]
    s_xor_b32 s32, s33, 0xf000
    s_add_u32 s34, s34, 1
    s_or_b32 s38, s34, 16
    s_add_u32 s61, s61, 1
    s_bitcmp1_b64 s[56:57], s61
    s_cbranch_scc1 L_p2_2_ev
L_p2_2_ev_back:
    v_and_b32_dpp v136, v173, v156 quad_perm:[1,1,1,1] row_mask:0xf bank_mask:0xf
    v_and_b32_dpp v137, v173, v157 quad_perm:[1,1,1,1] row_mask:0xf bank_mask:0xf
    v_and_b32_dpp v138, v173, v158 quad_perm:[1,1,1,1] row_mask:0xf bank_mask:0xf
    v_and_b32_dpp v139, v173, v159 quad_perm:[1,1,1,1] row_mask:0xf bank_mask:0xf
    s_waitcnt vmcnt(22)
    buffer_load_dwordx4 v[116:119], v169, s[24:27], s32 offen offset:0 nt
    v_mfma_f32_16x16x32_bf16 v[160:163], v[132:135], v[12:15], v[160:163]
    s_ff1_i32_b32 s38, s38
    s_mul_i32 s38, s38, 11
    s_waitcnt lgkmcnt(0)
    v_sub_f32 v174, v174, v164
    v_and_b32_dpp v132, v172, v156 quad_perm:[2,2,2,2] row_mask:0xf bank_mask:0xf
    v_and_b32_dpp v133, v172, v157 quad_perm:[2,2,2,2] row_mask:0xf bank_mask:0xf
    v_and_b32_dpp v134, v172, v158 quad_perm:[2,2,2,2] row_mask:0xf bank_mask:0xf
    v_and_b32_dpp v135, v172, v159 quad_perm:[2,2,2,2] row_mask:0xf bank_mask:0xf
    s_waitcnt vmcnt(22)
    buffer_load_dwordx4 v[120:123], v169, s[24:27], s32 offen offset:1024 nt
    v_mfma_f32_16x16x32_bf16 v[160:163], v[136:139], v[16:19], v[160:163]
    s_lshr_b64 s[38:39], s[36:37], s38
    s_and_b32 s38, s38, 0x7ff
    v_exp_f32 v174, v174
    v_and_b32_dpp v136, v173, v156 quad_perm:[2,2,2,2] row_mask:0xf bank_mask:0xf
    v_and_b32_dpp v137, v173, v157 quad_perm:[2,2,2,2] row_mask:0xf bank_mask:0xf
    v_and_b32_dpp v138, v173, v158 quad_perm:[2,2,2,2] row_mask:0xf bank_mask:0xf
    v_and_b32_dpp v139, v173, v159 quad_perm:[2,2,2,2] row_mask:0xf bank_mask:0xf
    s_waitcnt vmcnt(22)
    buffer_load_dwordx4 v[124:127], v169, s[24:27], s32 offen offset:2048 nt
    v_mfma_f32_16x16x32_bf16 v[160:163], v[132:135], v[20:23], v[160:163]
    s_lshl_b32 s38, s38, 12
    s_xor_b32 s33, s33, s38
    v_and_b32_dpp v132, v172, v156 quad_perm:[3,3,3,3] row_mask:0xf bank_mask:0xf
    v_and_b32_dpp v133, v172, v157 quad_perm:[3,3,3,3] row_mask:0xf bank_mask:0xf
    v_and_b32_dpp v134, v172, v158 quad_perm:[3,3,3,3] row_mask:0xf bank_mask:0xf
    v_and_b32_dpp v135, v172, v159 quad_perm:[3,3,3,3] row_mask:0xf bank_mask:0xf
    v_cvt_pk_bf16_f32 v172, v174, v174
    s_waitcnt vmcnt(22)
    buffer_load_dwordx4 v[128:131], v169, s[24:27], s32 offen offset:3072 nt
    v_mfma_f32_16x16x32_bf16 v[160:163], v[136:139], v[24:27], v[160:163]
    s_mov_b32 s32, s33
    s_cmp_eq_u32 s61, 64
    s_cbranch_scc1 L_tail
    v_mov_b32_dpp v172, v172 row_shr:4 row_mask:0xf bank_mask:0xa
    v_and_b32_dpp v136, v173, v156 quad_perm:[3,3,3,3] row_mask:0xf bank_mask:0xf
    v_and_b32_dpp v137, v173, v157 quad_perm:[3,3,3,3] row_mask:0xf bank_mask:0xf
    v_and_b32_dpp v138, v173, v158 quad_perm:[3,3,3,3] row_mask:0xf bank_mask:0xf
    v_and_b32_dpp v139, v173, v159 quad_perm:[3,3,3,3] row_mask:0xf bank_mask:0xf
    v_cvt_pk_bf16_f32 v173, v174, v174
    s_waitcnt vmcnt(22)
    buffer_load_dwordx4 v[4:7], v169, s[24:27], s32 offen offset:0 nt
    v_mfma_f32_16x16x32_bf16 v[160:163], v[132:135], v[28:31], v[160:163]
    v_and_b32_dpp v132, v172, v156 quad_perm:[0,0,0,0] row_mask:0xf bank_mask:0xf
    v_and_b32_dpp v133, v172, v157 quad_perm:[0,0,0,0] row_mask:0xf bank_mask:0xf
    v_and_b32_dpp v134, v172, v158 quad_perm:[0,0,0,0] row_mask:0xf bank_mask:0xf
    v_and_b32_dpp v135, v172, v159 quad_perm:[0,0,0,0] row_mask:0xf bank_mask:0xf
    v_mov_b32_dpp v173, v173 row_shl:4 row_mask:0xf bank_mask:0x5
    s_waitcnt vmcnt(22)
    buffer_load_dwordx4 v[8:11], v169, s[24:27], s32 offen offset:1024 nt
    v_mfma_f32_16x16x32_bf16 v[160:163], v[136:139], v[32:35], v[160:163]
    ds_read_b32 v174, v171 offset:512
    v_and_b32_dpp v136, v173, v156 quad_perm:[0,0,0,0] row_mask:0xf bank_mask:0xf
    v_and_b32_dpp v137, v173, v157 quad_perm:[0,0,0,0] row_mask:0xf bank_mask:0xf
    v_and_b32_dpp v138, v173, v158 quad_perm:[0,0,0,0] row_mask:0xf bank_mask:0xf
    v_and_b32_dpp v139, v173, v159 quad_perm:[0,0,0,0] row_mask:0xf bank_mask:0xf
    s_waitcnt vmcnt(22)
    buffer_load_dwordx4 v[12:15], v169, s[24:27], s32 offen offset:2048 nt
    v_mfma_f32_16x16x32_bf16 v[160:163], v[132:135], v[36:39], v[160:163]
    v_and_b32_dpp v132, v172, v156 quad_perm:[1,1,1,1] row_mask:0xf bank_mask:0xf
    v_and_b32_dpp v133, v172, v157 quad_perm:[1,1,1,1] row_mask:0xf bank_mask:0xf
    v_and_b32_dpp v134, v172, v158 quad_perm:[1,1,1,1] row_mask:0xf bank_mask:0xf
    v_and_b32_dpp v135, v172, v159 quad_perm:[1,1,1,1] row_mask:0xf bank_mask:0xf
    s_waitcnt vmcnt(22)
    buffer_load_dwordx4 v[16:19], v169, s[24:27], s32 offen offset:3072 nt
    v_mfma_f32_16x16x32_bf16 v[160:163], v[136:139], v[40:43], v[160:163]
    s_xor_b32 s32, s33, 0x8000
    v_and_b32_dpp v136, v173, v156 quad_perm:[1,1,1,1] row_mask:0xf bank_mask:0xf
    v_and_b32_dpp v137, v173, v157 quad_perm:[1,1,1,1] row_mask:0xf bank_mask:0xf
    v_and_b32_dpp v138, v173, v158 quad_perm:[1,1,1,1] row_mask:0xf bank_mask:0xf
    v_and_b32_dpp v139, v173, v159 quad_perm:[1,1,1,1] row_mask:0xf bank_mask:0xf
    s_waitcnt vmcnt(22)
    buffer_load_dwordx4 v[20:23], v169, s[24:27], s32 offen offset:0 nt
    v_mfma_f32_16x16x32_bf16 v[160:163], v[132:135], v[44:47], v[160:163]
    s_waitcnt lgkmcnt(0)
    v_sub_f32 v174, v174, v164
    v_and_b32_dpp v132, v172, v156 quad_perm:[2,2,2,2] row_mask:0xf bank_mask:0xf
    v_and_b32_dpp v133, v172, v157 quad_perm:[2,2,2,2] row_mask:0xf bank_mask:0xf
    v_and_b32_dpp v134, v172, v158 quad_perm:[2,2,2,2] row_mask:0xf bank_mask:0xf
    v_and_b32_dpp v135, v172, v159 quad_perm:[2,2,2,2] row_mask:0xf bank_mask:0xf
    s_waitcnt vmcnt(22)
    buffer_load_dwordx4 v[24:27], v169, s[24:27], s32 offen offset:1024 nt
    v_mfma_f32_16x16x32_bf16 v[160:163], v[136:139], v[48:51], v[160:163]
    v_exp_f32 v174, v174
    v_and_b32_dpp v136, v173, v156 quad_perm:[2,2,2,2] row_mask:0xf bank_mask:0xf
    v_and_b32_dpp v137, v173, v157 quad_perm:[2,2,2,2] row_mask:0xf bank_mask:0xf
    v_and_b32_dpp v138, v173, v158 quad_perm:[2,2,2,2] row_mask:0xf bank_mask:0xf
    v_and_b32_dpp v139, v173, v159 quad_perm:[2,2,2,2] row_mask:0xf bank_mask:0xf
    s_waitcnt vmcnt(22)
    buffer_load_dwordx4 v[28:31], v169, s[24:27], s32 offen offset:2048 nt
    v_mfma_f32_16x16x32_bf16 v[160:163], v[132:135], v[52:55], v[160:163]
    v_and_b32_dpp v132, v172, v156 quad_perm:[3,3,3,3] row_mask:0xf bank_mask:0xf
    v_and_b32_dpp v133, v172, v157 quad_perm:[3,3,3,3] row_mask:0xf bank_mask:0xf
    v_and_b32_dpp v134, v172, v158 quad_perm:[3,3,3,3] row_mask:0xf bank_mask:0xf
    v_and_b32_dpp v135, v172, v159 quad_perm:[3,3,3,3] row_mask:0xf bank_mask:0xf
    v_cvt_pk_bf16_f32 v172, v174, v174
    s_waitcnt vmcnt(22)
    buffer_load_dwordx4 v[32:35], v169, s[24:27], s32 offen offset:3072 nt
    v_mfma_f32_16x16x32_bf16 v[160:163], v[136:139], v[56:59], v[160:163]
    s_xor_b32 s32, s33, 0x1000
    v_mov_b32_dpp v172, v172 row_shr:4 row_mask:0xf bank_mask:0xa
    v_and_b32_dpp v136, v173, v156 quad_perm:[3,3,3,3] row_mask:0xf bank_mask:0xf
    v_and_b32_dpp v137, v173, v157 quad_perm:[3,3,3,3] row_mask:0xf bank_mask:0xf
    v_and_b32_dpp v138, v173, v158 quad_perm:[3,3,3,3] row_mask:0xf bank_mask:0xf
    v_and_b32_dpp v139, v173, v159 quad_perm:[3,3,3,3] row_mask:0xf bank_mask:0xf
    v_cvt_pk_bf16_f32 v173, v174, v174
    s_waitcnt vmcnt(22)
    buffer_load_dwordx4 v[36:39], v169, s[24:27], s32 offen offset:0 nt
    v_mfma_f32_16x16x32_bf16 v[160:163], v[132:135], v[60:63], v[160:163]
    v_and_b32_dpp v132, v172, v156 quad_perm:[0,0,0,0] row_mask:0xf bank_mask:0xf
    v_and_b32_dpp v133, v172, v157 quad_perm:[0,0,0,0] row_mask:0xf bank_mask:0xf
    v_and_b32_dpp v134, v172, v158 quad_perm:[0,0,0,0] row_mask:0xf bank_mask:0xf
    v_and_b32_dpp v135, v172, v159 quad_perm:[0,0,0,0] row_mask:0xf bank_mask:0xf
    v_mov_b32_dpp v173, v173 row_shl:4 row_mask:0xf bank_mask:0x5
    s_waitcnt vmcnt(22)
    buffer_load_dwordx4 v[40:43], v169, s[24:27], s32 offen offset:1024 nt
    v_mfma_f32_16x16x32_bf16 v[160:163], v[136:139], v[64:67], v[160:163]
    ds_read_b32 v174, v171 offset:768
    v_and_b32_dpp v136, v173, v156 quad_perm:[0,0,0,0] row_mask:0xf bank_mask:0xf
    v_and_b32_dpp v137, v173, v157 quad_perm:[0,0,0,0] row_mask:0xf bank_mask:0xf
    v_and_b32_dpp v138, v173, v158 quad_perm:[0,0,0,0] row_mask:0xf bank_mask:0xf
    v_and_b32_dpp v139, v173, v159 quad_perm:[0,0,0,0] row_mask:0xf bank_mask:0xf
    s_waitcnt vmcnt(22)
    buffer_load_dwordx4 v[44:47], v169, s[24:27], s32 offen offset:2048 nt
    v_mfma_f32_16x16x32_bf16 v[160:163], v[132:135], v[68:71], v[160:163]
    s_cmp_eq_u32 s61, 63
    s_cbranch_scc1 L_p2_2_tk
L_p2_2_tk_back:
    v_and_b32_dpp v132, v172, v156 quad_perm:[1,1,1,1] row_mask:0xf bank_mask:0xf
    v_and_b32_dpp v133, v172, v157 quad_perm:[1,1,1,1] row_mask:0xf bank_mask:0xf
    v_and_b32_dpp v134, v172, v158 quad_perm:[1,1,1,1] row_mask:0xf bank_mask:0xf
    v_and_b32_dpp v135, v172, v159 quad_perm:[1,1,1,1] row_mask:0xf bank_mask:0xf
    s_waitcnt vmcnt(22)
    buffer_load_dwordx4 v[48:51], v169, s[24:27], s32 offen offset:3072 nt
    v_mfma_f32_16x16x32_bf16 v[160:163], v[136:139], v[72:75], v[160:163]
    s_xor_b32 s32, s33, 0x9000
    v_and_b32_dpp v136, v173, v156 quad_perm:[1,1,1,1] row_mask:0xf bank_mask:0xf
    v_and_b32_dpp v137, v173, v157 quad_perm:[1,1,1,1] row_mask:0xf bank_mask:0xf
    v_and_b32_dpp v138, v173, v158 quad_perm:[1,1,1,1] row_mask:0xf bank_mask:0xf
    v_and_b32_dpp v139, v173, v159 quad_perm:[1,1,1,1] row_mask:0xf bank_mask:0xf
    s_waitcnt vmcnt(22)
    buffer_load_dwordx4 v[52:55], v169, s[24:27], s32 offen offset:0 nt
    v_mfma_f32_16x16x32_bf16 v[160:163], v[132:135], v[76:79], v[160:163]
    s_waitcnt lgkmcnt(0)
    v_sub_f32 v174, v174, v164
    v_and_b32_dpp v132, v172, v156 quad_perm:[2,2,2,2] row_mask:0xf bank_mask:0xf
    v_and_b32_dpp v133, v172, v157 quad_perm:[2,2,2,2] row_mask:0xf bank_mask:0xf
    v_and_b32_dpp v134, v172, v158 quad_perm:[2,2,2,2] row_mask:0xf bank_mask:0xf
    v_and_b32_dpp v135, v172, v159 quad_perm:[2,2,2,2] row_mask:0xf bank_mask:0xf
    s_waitcnt vmcnt(22)
    buffer_load_dwordx4 v[56:59], v169, s[24:27], s32 offen offset:1024 nt
    v_mfma_f32_16x16x32_bf16 v[160:163], v[136:139], v[80:83], v[160:163]
    v_exp_f32 v174, v174
    v_and_b32_dpp v136, v173, v156 quad_perm:[2,2,2,2] row_mask:0xf bank_mask:0xf
    v_and_b32_dpp v137, v173, v157 quad_perm:[2,2,2,2] row_mask:0xf bank_mask:0xf
    v_and_b32_dpp v138, v173, v158 quad_perm:[2,2,2,2] row_mask:0xf bank_mask:0xf
    v_and_b32_dpp v139, v173, v159 quad_perm:[2,2,2,2] row_mask:0xf bank_mask:0xf
    s_waitcnt vmcnt(22)
    buffer_load_dwordx4 v[60:63], v169, s[24:27], s32 offen offset:2048 nt
    v_mfma_f32_16x16x32_bf16 v[160:163], v[132:135], v[84:87], v[160:163]
    v_and_b32_dpp v132, v172, v156 quad_perm:[3,3,3,3] row_mask:0xf bank_mask:0xf
    v_and_b32_dpp v133, v172, v157 quad_perm:[3,3,3,3] row_mask:0xf bank_mask:0xf
    v_and_b32_dpp v134, v172, v158 quad_perm:[3,3,3,3] row_mask:0xf bank_mask:0xf
    v_and_b32_dpp v135, v172, v159 quad_perm:[3,3,3,3] row_mask:0xf bank_mask:0xf
    v_cvt_pk_bf16_f32 v172, v174, v174
    s_waitcnt vmcnt(22)
    buffer_load_dwordx4 v[64:67], v169, s[24:27], s32 offen offset:3072 nt
    v_mfma_f32_16x16x32_bf16 v[160:163], v[136:139], v[88:91], v[160:163]
    s_xor_b32 s32, s33, 0x6000
    v_mov_b32_dpp v172, v172 row_shr:4 row_mask:0xf bank_mask:0xa
    v_and_b32_dpp v136, v173, v156 quad_perm:[3,3,3,3] row_mask:0xf bank_mask:0xf
    v_and_b32_dpp v137, v173, v157 quad_perm:[3,3,3,3] row_mask:0xf bank_mask:0xf
    v_and_b32_dpp v138, v173, v158 quad_perm:[3,3,3,3] row_mask:0xf bank_mask:0xf
    v_and_b32_dpp v139, v173, v159 quad_perm:[3,3,3,3] row_mask:0xf bank_mask:0xf
    v_cvt_pk_bf16_f32 v173, v174, v174
    s_waitcnt vmcnt(22)
    buffer_load_dwordx4 v[68:71], v169, s[24:27], s32 offen offset:0 nt
    v_mfma_f32_16x16x32_bf16 v[160:163], v[132:135], v[92:95], v[160:163]
    v_and_b32_dpp v132, v172, v156 quad_perm:[0,0,0,0] row_mask:0xf bank_mask:0xf
    v_and_b32_dpp v133, v172, v157 quad_perm:[0,0,0,0] row_mask:0xf bank_mask:0xf
    v_and_b32_dpp v134, v172, v158 quad_perm:[0,0,0,0] row_mask:0xf bank_mask:0xf
    v_and_b32_dpp v135, v172, v159 quad_perm:[0,0,0,0] row_mask:0xf bank_mask:0xf
    v_mov_b32_dpp v173, v173 row_shl:4 row_mask:0xf bank_mask:0x5
    s_waitcnt vmcnt(22)
    buffer_load_dwordx4 v[72:75], v169, s[24:27], s32 offen offset:1024 nt
    v_mfma_f32_16x16x32_bf16 v[160:163], v[136:139], v[96:99], v[160:163]
    ds_read_b32 v174, v171 offset:1024
    v_and_b32_dpp v136, v173, v156 quad_perm:[0,0,0,0] row_mask:0xf bank_mask:0xf
    v_and_b32_dpp v137, v173, v157 quad_perm:[0,0,0,0] row_mask:0xf bank_mask:0xf
    v_and_b32_dpp v138, v173, v158 quad_perm:[0,0,0,0] row_mask:0xf bank_mask:0xf
    v_and_b32_dpp v139, v173, v159 quad_perm:[0,0,0,0] row_mask:0xf bank_mask:0xf
    s_waitcnt vmcnt(22)
    buffer_load_dwordx4 v[76:79], v169, s[24:27], s32 offen offset:2048 nt
    v_mfma_f32_16x16x32_bf16 v[160:163], v[132:135], v[100:103], v[160:163]
    v_and_b32_dpp v132, v172, v156 quad_perm:[1,1,1,1] row_mask:0xf bank_mask:0xf
    v_and_b32_dpp v133, v172, v157 quad_perm:[1,1,1,1] row_mask:0xf bank_mask:0xf
    v_and_b32_dpp v134, v172, v158 quad_perm:[1,1,1,1] row_mask:0xf bank_mask:0xf
    v_and_b32_dpp v135, v172, v159 quad_perm:[1,1,1,1] row_mask:0xf bank_mask:0xf
    s_waitcnt vmcnt(22)
    buffer_load_dwordx4 v[80:83], v169, s[24:27], s32 offen offset:3072 nt
    v_mfma_f32_16x16x32_bf16 v[160:163], v[136:139], v[104:107], v[160:163]
    s_xor_b32 s32, s33, 0xe000
    v_and_b32_dpp v136, v173, v156 quad_perm:[1,1,1,1] row_mask:0xf bank_mask:0xf
    v_and_b32_dpp v137, v173, v157 quad_perm:[1,1,1,1] row_mask:0xf bank_mask:0xf
    v_and_b32_dpp v138, v173, v158 quad_perm:[1,1,1,1] row_mask:0xf bank_mask:0xf
    v_and_b32_dpp v139, v173, v159 quad_perm:[1,1,1,1] row_mask:0xf bank_mask:0xf
    s_waitcnt vmcnt(22)
    buffer_load_dwordx4 v[84:87], v169, s[24:27], s32 offen offset:0 nt
    v_mfma_f32_16x16x32_bf16 v[160:163], v[132:135], v[108:111], v[160:163]
    s_waitcnt lgkmcnt(0)
    v_sub_f32 v174, v174, v164
    v_and_b32_dpp v132, v172, v156 quad_perm:[2,2,2,2] row_mask:0xf bank_mask:0xf
    v_and_b32_dpp v133, v172, v157 quad_perm:[2,2,2,2] row_mask:0xf bank_mask:0xf
    v_and_b32_dpp v134, v172, v158 quad_perm:[2,2,2,2] row_mask:0xf bank_mask:0xf
    v_and_b32_dpp v135, v172, v159 quad_perm:[2,2,2,2] row_mask:0xf bank_mask:0xf
    s_waitcnt vmcnt(22)
    buffer_load_dwordx4 v[88:91], v169, s[24:27], s32 offen offset:1024 nt
    v_mfma_f32_16x16x32_bf16 v[160:163], v[136:139], v[112:115], v[160:163]
    ds_read_b32 v175, v176 offset:34304
    v_exp_f32 v174, v174
    v_and_b32_dpp v136, v173, v156 quad_perm:[2,2,2,2] row_mask:0xf bank_mask:0xf
    v_and_b32_dpp v137, v173, v157 quad_perm:[2,2,2,2] row_mask:0xf bank_mask:0xf
    v_and_b32_dpp v138, v173, v158 quad_perm:[2,2,2,2] row_mask:0xf bank_mask:0xf
    v_and_b32_dpp v139, v173, v159 quad_perm:[2,2,2,2] row_mask:0xf bank_mask:0xf
    s_waitcnt vmcnt(22)
    buffer_load_dwordx4 v[92:95], v169, s[24:27], s32 offen offset:2048 nt
    v_mfma_f32_16x16x32_bf16 v[160:163], v[132:135], v[116:119], v[160:163]
    v_add_u32 v171, 1024, v171
    v_and_b32_dpp v132, v172, v156 quad_perm:[3,3,3,3] row_mask:0xf bank_mask:0xf
    v_and_b32_dpp v133, v172, v157 quad_perm:[3,3,3,3] row_mask:0xf bank_mask:0xf
    v_and_b32_dpp v134, v172, v158 quad_perm:[3,3,3,3] row_mask:0xf bank_mask:0xf
    v_and_b32_dpp v135, v172, v159 quad_perm:[3,3,3,3] row_mask:0xf bank_mask:0xf
    v_cvt_pk_bf16_f32 v172, v174, v174
    s_waitcnt vmcnt(22)
    buffer_load_dwordx4 v[96:99], v169, s[24:27], s32 offen offset:3072 nt
    v_mfma_f32_16x16x32_bf16 v[160:163], v[136:139], v[120:123], v[160:163]
    s_xor_b32 s32, s33, 0x7000
    s_waitcnt lgkmcnt(0)
    v_readfirstlane_b32 s60, v175
    v_mov_b32_dpp v172, v172 row_shr:4 row_mask:0xf bank_mask:0xa
    v_and_b32_dpp v136, v173, v156 quad_perm:[3,3,3,3] row_mask:0xf bank_mask:0xf
    v_and_b32_dpp v137, v173, v157 quad_perm:[3,3,3,3] row_mask:0xf bank_mask:0xf
    v_and_b32_dpp v138, v173, v158 quad_perm:[3,3,3,3] row_mask:0xf bank_mask:0xf
    v_and_b32_dpp v139, v173, v159 quad_perm:[3,3,3,3] row_mask:0xf bank_mask:0xf
    v_cvt_pk_bf16_f32 v173, v174, v174
    s_waitcnt vmcnt(22)
    buffer_load_dwordx4 v[100:103], v169, s[24:27], s32 offen offset:0 nt
    v_mfma_f32_16x16x32_bf16 v[160:163], v[132:135], v[124:127], v[160:163]
    s_lshr_b32 s22, s60, 2
    s_and_b32 s60, s60, 3
    s_cmp_ge_u32 s61, s22
    s_cselect_b32 s60, 1, s60
    s_cmp_ge_u32 s61, 62
    s_cselect_b32 s60, 2, s60
    v_and_b32_dpp v132, v172, v156 quad_perm:[0,0,0,0] row_mask:0xf bank_mask:0xf
    v_and_b32_dpp v133, v172, v157 quad_perm:[0,0,0,0] row_mask:0xf bank_mask:0xf
    v_and_b32_dpp v134, v172, v158 quad_perm:[0,0,0,0] row_mask:0xf bank_mask:0xf
    v_and_b32_dpp v135, v172, v159 quad_perm:[0,0,0,0] row_mask:0xf bank_mask:0xf
    v_mov_b32_dpp v173, v173 row_shl:4 row_mask:0xf bank_mask:0x5
    s_waitcnt vmcnt(22)
    buffer_load_dwordx4 v[104:107], v169, s[24:27], s32 offen offset:1024 nt
    v_mfma_f32_16x16x32_bf16 v[160:163], v[136:139], v[128:131], v[160:163]
    s_cmp_eq_u32 s60, 2
    s_cbranch_scc1 L_p2_2
    s_cmp_eq_u32 s60, 0
    s_cbranch_scc1 L_p2_0
    s_branch L_p2_1
L_tail:
    v_mov_b32_dpp v172, v172 row_shr:4 row_mask:0xf bank_mask:0xa
    v_and_b32_dpp v136, v173, v156 quad_perm:[3,3,3,3] row_mask:0xf bank_mask:0xf
    v_and_b32_dpp v137, v173, v157 quad_perm:[3,3,3,3] row_mask:0xf bank_mask:0xf
    v_and_b32_dpp v138, v173, v158 quad_perm:[3,3,3,3] row_mask:0xf bank_mask:0xf
    v_and_b32_dpp v139, v173, v159 quad_perm:[3,3,3,3] row_mask:0xf bank_mask:0xf
    v_cvt_pk_bf16_f32 v173, v174, v174
    s_waitcnt vmcnt(25)
    v_mfma_f32_16x16x32_bf16 v[160:163], v[132:135], v[28:31], v[160:163]
    v_and_b32_dpp v132, v172, v156 quad_perm:[0,0,0,0] row_mask:0xf bank_mask:0xf
    v_and_b32_dpp v133, v172, v157 quad_perm:[0,0,0,0] row_mask:0xf bank_mask:0xf
    v_and_b32_dpp v134, v172, v158 quad_perm:[0,0,0,0] row_mask:0xf bank_mask:0xf
    v_and_b32_dpp v135, v172, v159 quad_perm:[0,0,0,0] row_mask:0xf bank_mask:0xf
    v_mov_b32_dpp v173, v173 row_shl:4 row_mask:0xf bank_mask:0x5
    s_waitcnt vmcnt(24)
    v_mfma_f32_16x16x32_bf16 v[160:163], v[136:139], v[32:35], v[160:163]
    ds_read_b32 v174, v171 offset:512
    v_and_b32_dpp v136, v173, v156 quad_perm:[0,0,0,0] row_mask:0xf bank_mask:0xf
    v_and_b32_dpp v137, v173, v157 quad_perm:[0,0,0,0] row_mask:0xf bank_mask:0xf
    v_and_b32_dpp v138, v173, v158 quad_perm:[0,0,0,0] row_mask:0xf bank_mask:0xf
    v_and_b32_dpp v139, v173, v159 quad_perm:[0,0,0,0] row_mask:0xf bank_mask:0xf
    s_waitcnt vmcnt(23)
    v_mfma_f32_16x16x32_bf16 v[160:163], v[132:135], v[36:39], v[160:163]
    v_and_b32_dpp v132, v172, v156 quad_perm:[1,1,1,1] row_mask:0xf bank_mask:0xf
    v_and_b32_dpp v133, v172, v157 quad_perm:[1,1,1,1] row_mask:0xf bank_mask:0xf
    v_and_b32_dpp v134, v172, v158 quad_perm:[1,1,1,1] row_mask:0xf bank_mask:0xf
    v_and_b32_dpp v135, v172, v159 quad_perm:[1,1,1,1] row_mask:0xf bank_mask:0xf
    s_waitcnt vmcnt(22)
    v_mfma_f32_16x16x32_bf16 v[160:163], v[136:139], v[40:43], v[160:163]
    v_and_b32_dpp v136, v173, v156 quad_perm:[1,1,1,1] row_mask:0xf bank_mask:0xf
    v_and_b32_dpp v137, v173, v157 quad_perm:[1,1,1,1] row_mask:0xf bank_mask:0xf
    v_and_b32_dpp v138, v173, v158 quad_perm:[1,1,1,1] row_mask:0xf bank_mask:0xf
    v_and_b32_dpp v139, v173, v159 quad_perm:[1,1,1,1] row_mask:0xf bank_mask:0xf
    s_waitcnt vmcnt(21)
    v_mfma_f32_16x16x32_bf16 v[160:163], v[132:135], v[44:47], v[160:163]
    s_waitcnt lgkmcnt(0)
    v_sub_f32 v174, v174, v164
    v_and_b32_dpp v132, v172, v156 quad_perm:[2,2,2,2] row_mask:0xf bank_mask:0xf
    v_and_b32_dpp v133, v172, v157 quad_perm:[2,2,2,2] row_mask:0xf bank_mask:0xf
    v_and_b32_dpp v134, v172, v158 quad_perm:[2,2,2,2] row_mask:0xf bank_mask:0xf
    v_and_b32_dpp v135, v172, v159 quad_perm:[2,2,2,2] row_mask:0xf bank_mask:0xf
    s_waitcnt vmcnt(20)
    v_mfma_f32_16x16x32_bf16 v[160:163], v[136:139], v[48:51], v[160:163]
    v_exp_f32 v174, v174
    v_and_b32_dpp v136, v173, v156 quad_perm:[2,2,2,2] row_mask:0xf bank_mask:0xf
    v_and_b32_dpp v137, v173, v157 quad_perm:[2,2,2,2] row_mask:0xf bank_mask:0xf
    v_and_b32_dpp v138, v173, v158 quad_perm:[2,2,2,2] row_mask:0xf bank_mask:0xf
    v_and_b32_dpp v139, v173, v159 quad_perm:[2,2,2,2] row_mask:0xf bank_mask:0xf
    s_waitcnt vmcnt(19)
    v_mfma_f32_16x16x32_bf16 v[160:163], v[132:135], v[52:55], v[160:163]
    v_and_b32_dpp v132, v172, v156 quad_perm:[3,3,3,3] row_mask:0xf bank_mask:0xf
    v_and_b32_dpp v133, v172, v157 quad_perm:[3,3,3,3] row_mask:0xf bank_mask:0xf
    v_and_b32_dpp v134, v172, v158 quad_perm:[3,3,3,3] row_mask:0xf bank_mask:0xf
    v_and_b32_dpp v135, v172, v159 quad_perm:[3,3,3,3] row_mask:0xf bank_mask:0xf
    v_cvt_pk_bf16_f32 v172, v174, v174
    s_waitcnt vmcnt(18)
    v_mfma_f32_16x16x32_bf16 v[160:163], v[136:139], v[56:59], v[160:163]
    v_mov_b32_dpp v172, v172 row_shr:4 row_mask:0xf bank_mask:0xa
    v_and_b32_dpp v136, v173, v156 quad_perm:[3,3,3,3] row_mask:0xf bank_mask:0xf
    v_and_b32_dpp v137, v173, v157 quad_perm:[3,3,3,3] row_mask:0xf bank_mask:0xf
    v_and_b32_dpp v138, v173, v158 quad_perm:[3,3,3,3] row_mask:0xf bank_mask:0xf
    v_and_b32_dpp v139, v173, v159 quad_perm:[3,3,3,3] row_mask:0xf bank_mask:0xf
    v_cvt_pk_bf16_f32 v173, v174, v174
    s_waitcnt vmcnt(17)
    v_mfma_f32_16x16x32_bf16 v[160:163], v[132:135], v[60:63], v[160:163]
    v_and_b32_dpp v132, v172, v156 quad_perm:[0,0,0,0] row_mask:0xf bank_mask:0xf
    v_and_b32_dpp v133, v172, v157 quad_perm:[0,0,0,0] row_mask:0xf bank_mask:0xf
    v_and_b32_dpp v134, v172, v158 quad_perm:[0,0,0,0] row_mask:0xf bank_mask:0xf
    v_and_b32_dpp v135, v172, v159 quad_perm:[0,0,0,0] row_mask:0xf bank_mask:0xf
    v_mov_b32_dpp v173, v173 row_shl:4 row_mask:0xf bank_mask:0x5
    s_waitcnt vmcnt(16)
    v_mfma_f32_16x16x32_bf16 v[160:163], v[136:139], v[64:67], v[160:163]
    ds_read_b32 v174, v171 offset:768
    v_and_b32_dpp v136, v173, v156 quad_perm:[0,0,0,0] row_mask:0xf bank_mask:0xf
    v_and_b32_dpp v137, v173, v157 quad_perm:[0,0,0,0] row_mask:0xf bank_mask:0xf
    v_and_b32_dpp v138, v173, v158 quad_perm:[0,0,0,0] row_mask:0xf bank_mask:0xf
    v_and_b32_dpp v139, v173, v159 quad_perm:[0,0,0,0] row_mask:0xf bank_mask:0xf
    s_waitcnt vmcnt(15)
    v_mfma_f32_16x16x32_bf16 v[160:163], v[132:135], v[68:71], v[160:163]
    v_and_b32_dpp v132, v172, v156 quad_perm:[1,1,1,1] row_mask:0xf bank_mask:0xf
    v_and_b32_dpp v133, v172, v157 quad_perm:[1,1,1,1] row_mask:0xf bank_mask:0xf
    v_and_b32_dpp v134, v172, v158 quad_perm:[1,1,1,1] row_mask:0xf bank_mask:0xf
    v_and_b32_dpp v135, v172, v159 quad_perm:[1,1,1,1] row_mask:0xf bank_mask:0xf
    s_waitcnt vmcnt(14)
    v_mfma_f32_16x16x32_bf16 v[160:163], v[136:139], v[72:75], v[160:163]
    v_and_b32_dpp v136, v173, v156 quad_perm:[1,1,1,1] row_mask:0xf bank_mask:0xf
    v_and_b32_dpp v137, v173, v157 quad_perm:[1,1,1,1] row_mask:0xf bank_mask:0xf
    v_and_b32_dpp v138, v173, v158 quad_perm:[1,1,1,1] row_mask:0xf bank_mask:0xf
    v_and_b32_dpp v139, v173, v159 quad_perm:[1,1,1,1] row_mask:0xf bank_mask:0xf
    s_waitcnt vmcnt(13)
    v_mfma_f32_16x16x32_bf16 v[160:163], v[132:135], v[76:79], v[160:163]
    s_waitcnt lgkmcnt(0)
    v_sub_f32 v174, v174, v164
    v_and_b32_dpp v132, v172, v156 quad_perm:[2,2,2,2] row_mask:0xf bank_mask:0xf
    v_and_b32_dpp v133, v172, v157 quad_perm:[2,2,2,2] row_mask:0xf bank_mask:0xf
    v_and_b32_dpp v134, v172, v158 quad_perm:[2,2,2,2] row_mask:0xf bank_mask:0xf
    v_and_b32_dpp v135, v172, v159 quad_perm:[2,2,2,2] row_mask:0xf bank_mask:0xf
    s_waitcnt vmcnt(12)
    v_mfma_f32_16x16x32_bf16 v[160:163], v[136:139], v[80:83], v[160:163]
    v_exp_f32 v174, v174
    v_and_b32_dpp v136, v173, v156 quad_perm:[2,2,2,2] row_mask:0xf bank_mask:0xf
    v_and_b32_dpp v137, v173, v157 quad_perm:[2,2,2,2] row_mask:0xf bank_mask:0xf
    v_and_b32_dpp v138, v173, v158 quad_perm:[2,2,2,2] row_mask:0xf bank_mask:0xf
    v_and_b32_dpp v139, v173, v159 quad_perm:[2,2,2,2] row_mask:0xf bank_mask:0xf
    s_waitcnt vmcnt(11)
    v_mfma_f32_16x16x32_bf16 v[160:163], v[132:135], v[84:87], v[160:163]
    v_and_b32_dpp v132, v172, v156 quad_perm:[3,3,3,3] row_mask:0xf bank_mask:0xf
    v_and_b32_dpp v133, v172, v157 quad_perm:[3,3,3,3] row_mask:0xf bank_mask:0xf
    v_and_b32_dpp v134, v172, v158 quad_perm:[3,3,3,3] row_mask:0xf bank_mask:0xf
    v_and_b32_dpp v135, v172, v159 quad_perm:[3,3,3,3] row_mask:0xf bank_mask:0xf
    v_cvt_pk_bf16_f32 v172, v174, v174
    s_waitcnt vmcnt(10)
    v_mfma_f32_16x16x32_bf16 v[160:163], v[136:139], v[88:91], v[160:163]
    v_mov_b32_dpp v172, v172 row_shr:4 row_mask:0xf bank_mask:0xa
    v_and_b32_dpp v136, v173, v156 quad_perm:[3,3,3,3] row_mask:0xf bank_mask:0xf
    v_and_b32_dpp v137, v173, v157 quad_perm:[3,3,3,3] row_mask:0xf bank_mask:0xf
    v_and_b32_dpp v138, v173, v158 quad_perm:[3,3,3,3] row_mask:0xf bank_mask:0xf
    v_and_b32_dpp v139, v173, v159 quad_perm:[3,3,3,3] row_mask:0xf bank_mask:0xf
    v_cvt_pk_bf16_f32 v173, v174, v174
    s_waitcnt vmcnt(9)
    v_mfma_f32_16x16x32_bf16 v[160:163], v[132:135], v[92:95], v[160:163]
    v_and_b32_dpp v132, v172, v156 quad_perm:[0,0,0,0] row_mask:0xf bank_mask:0xf
    v_and_b32_dpp v133, v172, v157 quad_perm:[0,0,0,0] row_mask:0xf bank_mask:0xf
    v_and_b32_dpp v134, v172, v158 quad_perm:[0,0,0,0] row_mask:0xf bank_mask:0xf
    v_and_b32_dpp v135, v172, v159 quad_perm:[0,0,0,0] row_mask:0xf bank_mask:0xf
    v_mov_b32_dpp v173, v173 row_shl:4 row_mask:0xf bank_mask:0x5
    s_waitcnt vmcnt(8)
    v_mfma_f32_16x16x32_bf16 v[160:163], v[136:139], v[96:99], v[160:163]
    v_and_b32_dpp v136, v173, v156 quad_perm:[0,0,0,0] row_mask:0xf bank_mask:0xf
    v_and_b32_dpp v137, v173, v157 quad_perm:[0,0,0,0] row_mask:0xf bank_mask:0xf
    v_and_b32_dpp v138, v173, v158 quad_perm:[0,0,0,0] row_mask:0xf bank_mask:0xf
    v_and_b32_dpp v139, v173, v159 quad_perm:[0,0,0,0] row_mask:0xf bank_mask:0xf
    s_waitcnt vmcnt(7)
    v_mfma_f32_16x16x32_bf16 v[160:163], v[132:135], v[100:103], v[160:163]
    v_and_b32_dpp v132, v172, v156 quad_perm:[1,1,1,1] row_mask:0xf bank_mask:0xf
    v_and_b32_dpp v133, v172, v157 quad_perm:[1,1,1,1] row_mask:0xf bank_mask:0xf
    v_and_b32_dpp v134, v172, v158 quad_perm:[1,1,1,1] row_mask:0xf bank_mask:0xf
    v_and_b32_dpp v135, v172, v159 quad_perm:[1,1,1,1] row_mask:0xf bank_mask:0xf
    s_waitcnt vmcnt(6)
    v_mfma_f32_16x16x32_bf16 v[160:163], v[136:139], v[104:107], v[160:163]
    v_and_b32_dpp v136, v173, v156 quad_perm:[1,1,1,1] row_mask:0xf bank_mask:0xf
    v_and_b32_dpp v137, v173, v157 quad_perm:[1,1,1,1] row_mask:0xf bank_mask:0xf
    v_and_b32_dpp v138, v173, v158 quad_perm:[1,1,1,1] row_mask:0xf bank_mask:0xf
    v_and_b32_dpp v139, v173, v159 quad_perm:[1,1,1,1] row_mask:0xf bank_mask:0xf
    s_waitcnt vmcnt(5)
    v_mfma_f32_16x16x32_bf16 v[160:163], v[132:135], v[108:111], v[160:163]
    v_and_b32_dpp v132, v172, v156 quad_perm:[2,2,2,2] row_mask:0xf bank_mask:0xf
    v_and_b32_dpp v133, v172, v157 quad_perm:[2,2,2,2] row_mask:0xf bank_mask:0xf
    v_and_b32_dpp v134, v172, v158 quad_perm:[2,2,2,2] row_mask:0xf bank_mask:0xf
    v_and_b32_dpp v135, v172, v159 quad_perm:[2,2,2,2] row_mask:0xf bank_mask:0xf
    s_waitcnt vmcnt(4)
    v_mfma_f32_16x16x32_bf16 v[160:163], v[136:139], v[112:115], v[160:163]
    s_barrier
    ds_read_b64 v[148:149], v176 offset:34312
    v_and_b32_dpp v136, v173, v156 quad_perm:[2,2,2,2] row_mask:0xf bank_mask:0xf
    v_and_b32_dpp v137, v173, v157 quad_perm:[2,2,2,2] row_mask:0xf bank_mask:0xf
    v_and_b32_dpp v138, v173, v158 quad_perm:[2,2,2,2] row_mask:0xf bank_mask:0xf
    v_and_b32_dpp v139, v173, v159 quad_perm:[2,2,2,2] row_mask:0xf bank_mask:0xf
    s_waitcnt vmcnt(3)
    v_mfma_f32_16x16x32_bf16 v[160:163], v[132:135], v[116:119], v[160:163]
    v_and_b32_dpp v132, v172, v156 quad_perm:[3,3,3,3] row_mask:0xf bank_mask:0xf
    v_and_b32_dpp v133, v172, v157 quad_perm:[3,3,3,3] row_mask:0xf bank_mask:0xf
    v_and_b32_dpp v134, v172, v158 quad_perm:[3,3,3,3] row_mask:0xf bank_mask:0xf
    v_and_b32_dpp v135, v172, v159 quad_perm:[3,3,3,3] row_mask:0xf bank_mask:0xf
    s_waitcnt vmcnt(2)
    v_mfma_f32_16x16x32_bf16 v[160:163], v[136:139], v[120:123], v[160:163]
    v_and_b32_dpp v136, v173, v156 quad_perm:[3,3,3,3] row_mask:0xf bank_mask:0xf
    v_and_b32_dpp v137, v173, v157 quad_perm:[3,3,3,3] row_mask:0xf bank_mask:0xf
    v_and_b32_dpp v138, v173, v158 quad_perm:[3,3,3,3] row_mask:0xf bank_mask:0xf
    v_and_b32_dpp v139, v173, v159 quad_perm:[3,3,3,3] row_mask:0xf bank_mask:0xf
    s_waitcnt vmcnt(1)
    v_mfma_f32_16x16x32_bf16 v[160:163], v[132:135], v[124:127], v[160:163]
    s_waitcnt lgkmcnt(0)
    v_readfirstlane_b32 s48, v148
    s_movk_i32 s22, -128
    s_waitcnt vmcnt(0)
    v_mfma_f32_16x16x32_bf16 v[160:163], v[136:139], v[128:131], v[160:163]
    s_cmp_lg_u32 s48, 0
    s_cbranch_scc1 L_local
    s_nop 5
    v_and_or_b32 v163, v163, s22, v149
    buffer_store_dwordx4 v[160:163], v170, s[28:31], s41 offen sc1
    s_endpgm
L_local:
    s_nop 5
    v_and_b32 v163, s22, v163
    ds_write_b128 v170, v[160:163] offset:33024
    s_waitcnt lgkmcnt(0)
    s_barrier
L_end:
    s_endpgm
L_p1_1_ev:
    s_barrier
    s_branch L_p1_1_ev_back
L_p1_1_toV:
    s_mov_b32 s24, s44
    s_mov_b32 s25, s45
    v_mov_b32 v169, v170
    s_branch L_p1_1_toV_back
L_p1_0_ev:
    s_barrier
    s_branch L_p1_0_ev_back
L_p1_0_toV:
    s_mov_b32 s24, s44
    s_mov_b32 s25, s45
    v_mov_b32 v169, v170
    s_branch L_p1_0_toV_back
L_p1_2_ev:
    s_barrier
    s_branch L_p1_2_ev_back
L_p1_2_toV:
    s_mov_b32 s24, s44
    s_mov_b32 s25, s45
    v_mov_b32 v169, v170
    s_branch L_p1_2_toV_back
L_p2_0_ev:
    s_barrier
    s_branch L_p2_0_ev_back
L_p2_0_tk:
    s_barrier
    s_branch L_p2_0_tk_back
L_p2_1_ev:
    s_barrier
    s_branch L_p2_1_ev_back
L_p2_1_tk:
    s_barrier
    s_branch L_p2_1_tk_back
L_p2_2_ev:
    s_barrier
    s_branch L_p2_2_ev_back
L_p2_2_tk:
    s_barrier
    s_branch L_p2_2_tk_back
L_helper:
    s_load_dwordx2 s[20:21], s[0:1], 64
    ds_write_b32 v176, v176 offset:34304
    ds_write_b32 v176, v176 offset:34312
    s_waitcnt lgkmcnt(0)
    s_barrier
    s_getpc_b64 s[62:63]
L_pc:
    s_sub_u32 s62, s62, L_pc-standalone__tree_speculative_verify_tree_attention_over_candidate_token_tree__decode_kernel
    s_subb_u32 s63, s63, 0
    s_lshl_b32 s22, s40, 6
    v_add_u32 v93, s22, v0
    v_mul_u32_u24 v93, L_last-standalone__tree_speculative_verify_tree_attention_over_candidate_token_tree__decode_kernel, v93
    v_lshrrev_b32 v93, 11, v93
    v_and_b32 v93, -4, v93
    global_load_dword v96, v93, s[62:63]
    s_barrier
    s_load_dword s46, s[14:15], 0
    s_add_u32 s28, s4, s23
    s_addc_u32 s29, s5, 0
    buffer_load_dwordx4 v[60:63], v167, s[28:31], 0 offen
    s_add_u32 s56, s16, s23
    s_addc_u32 s57, s17, 0
    s_mov_b32 s58, 512
    s_mov_b32 s59, 0x20000
    s_lshl_b32 s23, s40, 8
    s_add_u32 s28, s10, s23
    s_addc_u32 s29, s11, 0
    s_mov_b32 s30, 256
    buffer_load_dwordx4 v[64:67], v166, s[28:31], 0 offen
    v_and_b32 v3, 0xf0, v170
    s_add_u32 s28, s12, s23
    s_addc_u32 s29, s13, 0
    buffer_load_dwordx4 v[68:71], v3, s[28:31], 0 offen
    s_mul_i32 s22, s40, 8192
    s_add_u32 s28, s20, s22
    s_addc_u32 s29, s21, 0
    s_mov_b32 s30, 8192
    s_mul_i32 s41, s41, 1024
    buffer_load_dword v4, v170, s[28:31], s41 offen offset:12 sc1
    s_lshl_b32 s22, s2, 8
    s_add_u32 s22, s22, 1048576
    v_add_u32 v85, s22, v171
    v_and_b32 v1, 7, v0
    v_lshlrev_b32 v1, 8, v1
    v_xor_b32 v86, s22, v1
    v_and_b32 v1, 1, v0
    v_bfe_u32 v2, v0, 3, 1
    v_lshl_or_b32 v1, v2, 1, v1
    v_lshl_add_u32 v88, v1, 4, s22
    s_and_b32 s36, s40, 3
    v_add_u32 v91, 65536, v85
    s_and_b32 s22, s22, 0xffff07ff
    s_add_u32 s22, s22, 65536
    v_and_b32 v92, 0xffff07ff, v86
    s_cmp_eq_u32 s36, 0
    s_cbranch_scc1 L_isanchor
    v_mov_b32 v92, s22
L_isanchor:
    s_cmp_lg_u32 s36, 0
    s_cbranch_scc1 L_nopub_init
    s_mov_b64 exec, 0xffff
    global_store_dword v91, v176, s[20:21] sc1
    global_store_dword v85, v176, s[20:21] sc1
    s_waitcnt vmcnt(0)
    global_store_dword v91, v176, s[20:21]
L_nopub_init:
    s_mov_b64 exec, -1
    v_and_b32 v1, 1, v0
    v_lshlrev_b32 v1, 4, v1
    v_mov_b32 v2, 0xffff
    v_lshlrev_b32 v1, v1, v2
    v_bfe_u32 v2, v0, 1, 2
    v_cmp_eq_u32 vcc, 0, v2
    s_nop 1
    v_cndmask_b32 v156, 0, v1, vcc
    v_cmp_eq_u32 vcc, 1, v2
    s_nop 1
    v_cndmask_b32 v157, 0, v1, vcc
    v_cmp_eq_u32 vcc, 2, v2
    s_nop 1
    v_cndmask_b32 v158, 0, v1, vcc
    v_cmp_eq_u32 vcc, 3, v2
    s_nop 1
    v_cndmask_b32 v159, 0, v1, vcc
    v_mov_b32 v165, 0x3e0293ee
    v_lshrrev_b32 v1, 5, v0
    v_bfe_u32 v2, v0, 4, 1
    v_and_b32 v83, 0xf0, v170
    v_lshl_add_u32 v83, v2, 3, v83
    v_lshl_add_u32 v83, v1, 8, v83
    v_mov_b32 v1, 0x3e803e80
    v_and_b32 v76, v1, v156
    v_and_b32 v77, v1, v157
    v_and_b32 v78, v1, v158
    v_and_b32 v79, v1, v159
    s_waitcnt lgkmcnt(0)
    s_lshr_b32 s23, s40, 4
    s_lshl_b32 s23, s23, 4
    s_lshr_b32 s22, s46, s23
    s_lshl_b32 s22, s22, 16
    v_mov_b32 v82, s22
    v_sub_f32 v82, 1.0, v82
    v_mul_f32 v82, 0xceabfb8f, v82
    s_lshl_b32 s23, s40, 3
    v_mov_b32 v89, s23
    v_mov_b32 v90, 1
    s_mov_b32 s43, 1048576
    s_waitcnt vmcnt(0)
    v_mfma_f32_16x16x32_bf16 v[72:75], v[64:67], v[60:63], 0
    v_mfma_f32_16x16x32_bf16 v[36:39], v[76:79], v[68:71], 0
    s_nop 7
    v_fmac_f32_dpp v82, v72, v165 quad_perm:[0,0,0,0] row_mask:0xf bank_mask:0xf
    s_nop 1
    v_fmac_f32_dpp v82, v73, v165 quad_perm:[1,1,1,1] row_mask:0xf bank_mask:0xf
    s_nop 1
    v_fmac_f32_dpp v82, v74, v165 quad_perm:[2,2,2,2] row_mask:0xf bank_mask:0xf
    s_nop 1
    v_fmac_f32_dpp v82, v75, v165 quad_perm:[3,3,3,3] row_mask:0xf bank_mask:0xf
    s_nop 1
    v_mov_b32_dpp v82, v82 row_newbcast:0 row_mask:0x3 bank_mask:0xf
    s_nop 1
    v_mov_b32_dpp v82, v82 row_newbcast:8 row_mask:0xc bank_mask:0xf
    s_mov_b64 s[52:53], -1
    s_mov_b32 s50, 0
    v_and_b32 v1, 64, v4
    v_cmp_ne_u32 vcc, 0, v1
    s_andn2_b64 s[54:55], s[52:53], vcc
    s_and_b64 s[52:53], s[52:53], vcc
    s_bcnt1_i32_b64 s22, s[52:53]
    s_bcnt1_i32_b64 s23, s[54:55]
    s_cmp_lt_u32 s22, s23
    s_cselect_b64 s[52:53], s[52:53], s[54:55]
    s_addc_u32 s50, s50, s50
    v_and_b32 v1, 32, v4
    v_cmp_ne_u32 vcc, 0, v1
    s_andn2_b64 s[54:55], s[52:53], vcc
    s_and_b64 s[52:53], s[52:53], vcc
    s_bcnt1_i32_b64 s22, s[52:53]
    s_bcnt1_i32_b64 s23, s[54:55]
    s_cmp_lt_u32 s22, s23
    s_cselect_b64 s[52:53], s[52:53], s[54:55]
    s_addc_u32 s50, s50, s50
    v_and_b32 v1, 16, v4
    v_cmp_ne_u32 vcc, 0, v1
    s_andn2_b64 s[54:55], s[52:53], vcc
    s_and_b64 s[52:53], s[52:53], vcc
    s_bcnt1_i32_b64 s22, s[52:53]
    s_bcnt1_i32_b64 s23, s[54:55]
    s_cmp_lt_u32 s22, s23
    s_cselect_b64 s[52:53], s[52:53], s[54:55]
    s_addc_u32 s50, s50, s50
    v_and_b32 v1, 8, v4
    v_cmp_ne_u32 vcc, 0, v1
    s_andn2_b64 s[54:55], s[52:53], vcc
    s_and_b64 s[52:53], s[52:53], vcc
    s_bcnt1_i32_b64 s22, s[52:53]
    s_bcnt1_i32_b64 s23, s[54:55]
    s_cmp_lt_u32 s22, s23
    s_cselect_b64 s[52:53], s[52:53], s[54:55]
    s_addc_u32 s50, s50, s50
    v_and_b32 v1, 4, v4
    v_cmp_ne_u32 vcc, 0, v1
    s_andn2_b64 s[54:55], s[52:53], vcc
    s_and_b64 s[52:53], s[52:53], vcc
    s_bcnt1_i32_b64 s22, s[52:53]
    s_bcnt1_i32_b64 s23, s[54:55]
    s_cmp_lt_u32 s22, s23
    s_cselect_b64 s[52:53], s[52:53], s[54:55]
    s_addc_u32 s50, s50, s50
    v_and_b32 v1, 2, v4
    v_cmp_ne_u32 vcc, 0, v1
    s_andn2_b64 s[54:55], s[52:53], vcc
    s_and_b64 s[52:53], s[52:53], vcc
    s_bcnt1_i32_b64 s22, s[52:53]
    s_bcnt1_i32_b64 s23, s[54:55]
    s_cmp_lt_u32 s22, s23
    s_cselect_b64 s[52:53], s[52:53], s[54:55]
    s_addc_u32 s50, s50, s50
    v_and_b32 v1, 1, v4
    v_cmp_ne_u32 vcc, 0, v1
    s_andn2_b64 s[54:55], s[52:53], vcc
    s_and_b64 s[52:53], s[52:53], vcc
    s_bcnt1_i32_b64 s22, s[52:53]
    s_bcnt1_i32_b64 s23, s[54:55]
    s_cmp_lt_u32 s22, s23
    s_cselect_b64 s[52:53], s[52:53], s[54:55]
    s_addc_u32 s50, s50, s50
    v_mov_b32 v114, s50
    v_mov_b32 v115, 0
    ds_write_b32 v176, v114 offset:34316
    v_mov_b32 v87, 12
    s_lshr_b32 s22, s40, 2
    s_add_u32 s22, s22, 12
    v_add_u32 v1, s22, v0
    v_and_b32 v1, 7, v1
    v_lshl_or_b32 v1, v1, 13, v92
    s_mov_b32 s32, 0x81624924
    s_mov_b32 s33, 0x00008921
    s_barrier
    s_cmp_lg_u32 s36, 0
    s_cbranch_scc1 L_nopub_12
    s_mov_b64 exec, 0xffff
    global_store_dword v91, v87, s[20:21]
    global_store_dword v85, v87, s[20:21] sc1
L_nopub_12:
    s_mov_b64 exec, 0xfe
    global_load_dword v84, v1, s[20:21] sc1
    s_waitcnt vmcnt(0)
    v_cmp_ge_u32 vcc, v84, v87
    s_mov_b64 exec, -1
    s_bcnt1_i32_b32 s22, vcc_lo
    s_mul_i32 s22, s22, 6
    s_lshr_b64 s[32:33], s[32:33], s22
    s_and_b32 s22, s32, 63
    s_add_u32 s22, s22, 48
    v_mov_b32 v175, s22
    ds_write_b32 v176, v175 offset:34304
    v_mov_b32 v87, 21
    s_lshr_b32 s22, s40, 2
    s_add_u32 s22, s22, 21
    v_add_u32 v1, s22, v0
    v_and_b32 v1, 7, v1
    v_lshl_or_b32 v1, v1, 13, v92
    s_mov_b32 s32, 0x81624924
    s_mov_b32 s33, 0x00008921
    s_barrier
    s_cmp_lg_u32 s36, 0
    s_cbranch_scc1 L_nopub_21
    s_mov_b64 exec, 0xffff
    global_store_dword v91, v87, s[20:21]
    global_store_dword v85, v87, s[20:21] sc1
L_nopub_21:
    s_mov_b64 exec, 0xfe
    global_load_dword v84, v1, s[20:21] sc1
    s_waitcnt vmcnt(0)
    v_cmp_ge_u32 vcc, v84, v87
    s_mov_b64 exec, -1
    s_bcnt1_i32_b32 s22, vcc_lo
    s_mul_i32 s22, s22, 6
    s_lshr_b64 s[32:33], s[32:33], s22
    s_and_b32 s22, s32, 63
    s_add_u32 s22, s22, 84
    v_mov_b32 v175, s22
    ds_write_b32 v176, v175 offset:34304
    v_mov_b32 v87, 28
    s_lshr_b32 s22, s40, 2
    s_add_u32 s22, s22, 28
    v_add_u32 v1, s22, v0
    v_and_b32 v1, 7, v1
    v_lshl_or_b32 v1, v1, 13, v92
    s_mov_b32 s32, 0x81624924
    s_mov_b32 s33, 0x00008921
    s_barrier
    s_cmp_lg_u32 s36, 0
    s_cbranch_scc1 L_nopub_28
    s_mov_b64 exec, 0xffff
    global_store_dword v91, v87, s[20:21]
    global_store_dword v85, v87, s[20:21] sc1
L_nopub_28:
    s_mov_b64 exec, 0xfe
    global_load_dword v84, v1, s[20:21] sc1
    s_waitcnt vmcnt(0)
    v_cmp_ge_u32 vcc, v84, v87
    s_mov_b64 exec, -1
    s_bcnt1_i32_b32 s22, vcc_lo
    s_mul_i32 s22, s22, 6
    s_lshr_b64 s[32:33], s[32:33], s22
    s_and_b32 s22, s32, 63
    s_add_u32 s22, s22, 112
    v_mov_b32 v175, s22
    ds_write_b32 v176, v175 offset:34304
    s_barrier
    ds_read_b32 v112, v171 offset:34048
    v_mov_b32 v113, 0
    v_mov_b32 v1, v171
    s_mov_b32 s22, 8
L_hsum_loop:
    ds_read2st64_b32 v[96:97], v1 offset0:1 offset1:2
    ds_read2st64_b32 v[98:99], v1 offset0:3 offset1:4
    ds_read2st64_b32 v[100:101], v1 offset0:5 offset1:6
    ds_read2st64_b32 v[102:103], v1 offset0:7 offset1:8
    ds_read2st64_b32 v[104:105], v1 offset0:9 offset1:10
    ds_read2st64_b32 v[106:107], v1 offset0:11 offset1:12
    ds_read2st64_b32 v[108:109], v1 offset0:13 offset1:14
    ds_read2st64_b32 v[110:111], v1 offset0:15 offset1:16
    v_add_u32 v1, 4096, v1
    s_waitcnt lgkmcnt(0)
    v_sub_f32 v96, v96, v112
    v_sub_f32 v97, v97, v112
    v_sub_f32 v98, v98, v112
    v_sub_f32 v99, v99, v112
    v_sub_f32 v100, v100, v112
    v_sub_f32 v101, v101, v112
    v_sub_f32 v102, v102, v112
    v_sub_f32 v103, v103, v112
    v_sub_f32 v104, v104, v112
    v_sub_f32 v105, v105, v112
    v_sub_f32 v106, v106, v112
    v_sub_f32 v107, v107, v112
    v_sub_f32 v108, v108, v112
    v_sub_f32 v109, v109, v112
    v_sub_f32 v110, v110, v112
    v_sub_f32 v111, v111, v112
    v_exp_f32 v96, v96
    v_exp_f32 v97, v97
    v_exp_f32 v98, v98
    v_exp_f32 v99, v99
    v_exp_f32 v100, v100
    v_exp_f32 v101, v101
    v_exp_f32 v102, v102
    v_exp_f32 v103, v103
    v_exp_f32 v104, v104
    v_exp_f32 v105, v105
    v_exp_f32 v106, v106
    v_exp_f32 v107, v107
    v_exp_f32 v108, v108
    v_exp_f32 v109, v109
    v_exp_f32 v110, v110
    v_exp_f32 v111, v111
    v_add_f32 v113, v113, v96
    v_add_f32 v113, v113, v97
    v_add_f32 v113, v113, v98
    v_add_f32 v113, v113, v99
    v_add_f32 v113, v113, v100
    v_add_f32 v113, v113, v101
    v_add_f32 v113, v113, v102
    v_add_f32 v113, v113, v103
    v_add_f32 v113, v113, v104
    v_add_f32 v113, v113, v105
    v_add_f32 v113, v113, v106
    v_add_f32 v113, v113, v107
    v_add_f32 v113, v113, v108
    v_add_f32 v113, v113, v109
    v_add_f32 v113, v113, v110
    v_add_f32 v113, v113, v111
    s_sub_u32 s22, s22, 1
    s_cmp_lg_u32 s22, 0
    s_cbranch_scc1 L_hsum_loop
    s_nop 1
    v_add_f32_dpp v113, v113, v113 quad_perm:[1,0,3,2] row_mask:0xf bank_mask:0xf
    s_nop 1
    v_add_f32_dpp v113, v113, v113 quad_perm:[2,3,0,1] row_mask:0xf bank_mask:0xf
    s_nop 1
    v_add_f32_dpp v113, v113, v113 row_half_mirror row_mask:0xf bank_mask:0xf
    v_mov_b32 v166, v113
    s_nop 1
    v_permlane16_swap_b32 v166, v113
    v_add_f32 v113, v113, v166
    v_mov_b32 v166, v113
    s_nop 1
    v_permlane32_swap_b32 v166, v113
    v_add_f32 v113, v113, v166
    s_mov_b64 exec, 0x0303
    global_store_dwordx4 v88, v[112:115], s[20:21] offset:128 sc1
    s_mov_b64 exec, -1
    v_mov_b32 v87, 37
    s_lshr_b32 s22, s40, 2
    s_add_u32 s22, s22, 37
    v_add_u32 v1, s22, v0
    v_and_b32 v1, 7, v1
    v_lshl_or_b32 v1, v1, 13, v92
    s_mov_b32 s32, 0x81624924
    s_mov_b32 s33, 0x00008921
    s_barrier
    s_cmp_lg_u32 s36, 0
    s_cbranch_scc1 L_nopub_37
    s_mov_b64 exec, 0xffff
    global_store_dword v91, v87, s[20:21]
    global_store_dword v85, v87, s[20:21] sc1
L_nopub_37:
    s_mov_b64 exec, 0xfe
    global_load_dword v84, v1, s[20:21] sc1
    s_waitcnt vmcnt(0)
    v_cmp_ge_u32 vcc, v84, v87
    s_mov_b64 exec, -1
    s_bcnt1_i32_b32 s22, vcc_lo
    s_mul_i32 s22, s22, 6
    s_lshr_b64 s[32:33], s[32:33], s22
    s_and_b32 s22, s32, 63
    s_add_u32 s22, s22, 148
    v_mov_b32 v175, s22
    ds_write_b32 v176, v175 offset:34304
    v_mov_b32 v87, 46
    s_lshr_b32 s22, s40, 2
    s_add_u32 s22, s22, 46
    v_add_u32 v1, s22, v0
    v_and_b32 v1, 7, v1
    v_lshl_or_b32 v1, v1, 13, v92
    s_mov_b32 s32, 0x81624924
    s_mov_b32 s33, 0x00008921
    s_barrier
    s_cmp_lg_u32 s36, 0
    s_cbranch_scc1 L_nopub_46
    s_mov_b64 exec, 0xffff
    global_store_dword v91, v87, s[20:21]
    global_store_dword v85, v87, s[20:21] sc1
L_nopub_46:
    s_mov_b64 exec, 0xfe
    global_load_dword v84, v1, s[20:21] sc1
    s_waitcnt vmcnt(0)
    v_cmp_ge_u32 vcc, v84, v87
    s_mov_b64 exec, -1
    s_bcnt1_i32_b32 s22, vcc_lo
    s_mul_i32 s22, s22, 6
    s_lshr_b64 s[32:33], s[32:33], s22
    s_and_b32 s22, s32, 63
    s_add_u32 s22, s22, 184
    v_mov_b32 v175, s22
    ds_write_b32 v176, v175 offset:34304
    v_mov_b32 v87, 55
    s_lshr_b32 s22, s40, 2
    s_add_u32 s22, s22, 55
    v_add_u32 v1, s22, v0
    v_and_b32 v1, 7, v1
    v_lshl_or_b32 v1, v1, 13, v92
    s_mov_b32 s32, 0x81624924
    s_mov_b32 s33, 0x00008921
    s_barrier
    s_cmp_lg_u32 s36, 0
    s_cbranch_scc1 L_nopub_55
    s_mov_b64 exec, 0xffff
    global_store_dword v91, v87, s[20:21]
    global_store_dword v85, v87, s[20:21] sc1
L_nopub_55:
    s_mov_b64 exec, 0xfe
    global_load_dword v84, v1, s[20:21] sc1
    s_waitcnt vmcnt(0)
    v_cmp_ge_u32 vcc, v84, v87
    s_mov_b64 exec, -1
    s_bcnt1_i32_b32 s22, vcc_lo
    s_mul_i32 s22, s22, 6
    s_lshr_b64 s[32:33], s[32:33], s22
    s_and_b32 s22, s32, 63
    s_add_u32 s22, s22, 220
    v_mov_b32 v175, s22
    ds_write_b32 v176, v175 offset:34304
    s_barrier
    s_waitcnt vmcnt(0)
    s_mov_b64 exec, 1
    global_atomic_add v84, v89, v90, s[18:19] sc0
    s_mov_b64 exec, -1
    v_and_b32 v1, 32, v0
    v_add_u32 v1, v1, v86
    s_waitcnt vmcnt(0)
    v_readfirstlane_b32 s48, v84
    s_cmp_lg_u32 s36, 0
    s_cbranch_scc1 L_noclean
    s_mov_b64 exec, 0xffff
    global_store_dword v91, v87, s[20:21] sc1
    s_mov_b64 exec, -1
L_noclean:
    s_nop 3
    s_and_b32 s48, s48, 7
    s_cmp_lg_u32 s48, 7
    s_cbranch_scc0 L_merge
    s_barrier
    s_endpgm
L_merge:
    global_load_dwordx3 v[112:114], v1, s[20:21] offset:128 sc1
    ds_write_b32 v176, v90 offset:34312
    s_waitcnt lgkmcnt(0)
    s_barrier
    s_xor_b32 s22, s41, 1024
    buffer_load_dwordx4 v[8:11], v170, s[28:31], s22 offen sc1
    s_xor_b32 s22, s41, 2048
    buffer_load_dwordx4 v[12:15], v170, s[28:31], s22 offen sc1
    s_xor_b32 s22, s41, 3072
    buffer_load_dwordx4 v[16:19], v170, s[28:31], s22 offen sc1
    s_xor_b32 s22, s41, 4096
    buffer_load_dwordx4 v[20:23], v170, s[28:31], s22 offen sc1
    s_xor_b32 s22, s41, 5120
    buffer_load_dwordx4 v[24:27], v170, s[28:31], s22 offen sc1
    s_xor_b32 s22, s41, 6144
    buffer_load_dwordx4 v[28:31], v170, s[28:31], s22 offen sc1
    s_xor_b32 s22, s41, 7168
    buffer_load_dwordx4 v[32:35], v170, s[28:31], s22 offen sc1
    s_waitcnt vmcnt(7)
    v_readlane_b32 s33, v114, 1
    v_readlane_b32 s34, v114, 2
    v_readlane_b32 s35, v114, 3
    v_readlane_b32 s36, v114, 4
    v_readlane_b32 s37, v114, 5
    v_readlane_b32 s38, v114, 6
    v_readlane_b32 s39, v114, 7
    v_max_f32 v167, v112, v82
    s_nop 1
    v_max_f32_dpp v167, v167, v167 quad_perm:[1,0,3,2] row_mask:0xf bank_mask:0xf
    s_nop 1
    v_max_f32_dpp v167, v167, v167 quad_perm:[2,3,0,1] row_mask:0xf bank_mask:0xf
    s_nop 1
    v_max_f32_dpp v167, v167, v167 row_half_mirror row_mask:0xf bank_mask:0xf
    v_sub_f32 v112, v112, v167
    v_sub_f32 v82, v82, v167
    v_exp_f32 v112, v112
    v_exp_f32 v82, v82
    v_mul_f32 v113, v113, v112
    s_nop 1
    v_add_f32_dpp v113, v113, v113 quad_perm:[1,0,3,2] row_mask:0xf bank_mask:0xf
    s_nop 1
    v_add_f32_dpp v113, v113, v113 quad_perm:[2,3,0,1] row_mask:0xf bank_mask:0xf
    s_nop 1
    v_add_f32_dpp v113, v113, v113 row_half_mirror row_mask:0xf bank_mask:0xf
    v_add_f32 v113, v113, v82
    v_rcp_f32 v113, v113
    s_nop 0
    v_mul_f32 v112, v112, v113
    v_mul_f32 v82, v82, v113
    v_mul_f32 v36, v36, v82
    v_mul_f32 v37, v37, v82
    v_mul_f32 v38, v38, v82
    v_mul_f32 v39, v39, v82
    v_mov_b32_dpp v40, v112 row_newbcast:0 row_mask:0xf bank_mask:0xf
    v_mov_b32_dpp v41, v112 row_newbcast:0 row_mask:0xf bank_mask:0xf
    v_mov_b32_dpp v42, v112 row_newbcast:1 row_mask:0xf bank_mask:0xf
    v_mov_b32_dpp v43, v112 row_newbcast:1 row_mask:0xf bank_mask:0xf
    v_mov_b32_dpp v44, v112 row_newbcast:2 row_mask:0xf bank_mask:0xf
    v_mov_b32_dpp v45, v112 row_newbcast:2 row_mask:0xf bank_mask:0xf
    v_mov_b32_dpp v46, v112 row_newbcast:3 row_mask:0xf bank_mask:0xf
    v_mov_b32_dpp v47, v112 row_newbcast:3 row_mask:0xf bank_mask:0xf
    v_mov_b32_dpp v48, v112 row_newbcast:4 row_mask:0xf bank_mask:0xf
    v_mov_b32_dpp v49, v112 row_newbcast:4 row_mask:0xf bank_mask:0xf
    v_mov_b32_dpp v50, v112 row_newbcast:5 row_mask:0xf bank_mask:0xf
    v_mov_b32_dpp v51, v112 row_newbcast:5 row_mask:0xf bank_mask:0xf
    v_mov_b32_dpp v52, v112 row_newbcast:6 row_mask:0xf bank_mask:0xf
    v_mov_b32_dpp v53, v112 row_newbcast:6 row_mask:0xf bank_mask:0xf
    v_mov_b32_dpp v54, v112 row_newbcast:7 row_mask:0xf bank_mask:0xf
    v_mov_b32_dpp v55, v112 row_newbcast:7 row_mask:0xf bank_mask:0xf
    s_barrier
    ds_read_b128 v[4:7], v170 offset:33024
    s_branch L_check
L_poll:
    s_sub_u32 s43, s43, 1
    s_cbranch_scc1 L_end
    s_xor_b32 s22, s41, 1024
    buffer_load_dwordx4 v[8:11], v170, s[28:31], s22 offen sc1
    s_xor_b32 s22, s41, 2048
    buffer_load_dwordx4 v[12:15], v170, s[28:31], s22 offen sc1
    s_xor_b32 s22, s41, 3072
    buffer_load_dwordx4 v[16:19], v170, s[28:31], s22 offen sc1
    s_xor_b32 s22, s41, 4096
    buffer_load_dwordx4 v[20:23], v170, s[28:31], s22 offen sc1
    s_xor_b32 s22, s41, 5120
    buffer_load_dwordx4 v[24:27], v170, s[28:31], s22 offen sc1
    s_xor_b32 s22, s41, 6144
    buffer_load_dwordx4 v[28:31], v170, s[28:31], s22 offen sc1
    s_xor_b32 s22, s41, 7168
    buffer_load_dwordx4 v[32:35], v170, s[28:31], s22 offen sc1
L_check:
    s_waitcnt vmcnt(6)
    v_xor_b32 v11, s33, v11
    s_waitcnt vmcnt(5)
    v_xor_b32 v15, s34, v15
    s_waitcnt vmcnt(4)
    v_xor_b32 v19, s35, v19
    v_or3_b32 v166, v11, v15, v19
    s_waitcnt vmcnt(3)
    v_xor_b32 v23, s36, v23
    s_waitcnt vmcnt(2)
    v_xor_b32 v27, s37, v27
    v_or3_b32 v166, v166, v23, v27
    s_waitcnt vmcnt(1)
    v_xor_b32 v31, s38, v31
    s_waitcnt vmcnt(0)
    v_xor_b32 v35, s39, v35
    v_or3_b32 v166, v166, v31, v35
    v_and_b32 v166, 127, v166
    v_cmp_ne_u32 vcc, 0, v166
    s_cbranch_vccnz L_poll
    v_pk_mul_f32 v[8:9], v[8:9], v[42:43]
    v_pk_mul_f32 v[10:11], v[10:11], v[42:43]
    v_pk_mul_f32 v[12:13], v[12:13], v[44:45]
    v_pk_mul_f32 v[14:15], v[14:15], v[44:45]
    v_pk_mul_f32 v[16:17], v[16:17], v[46:47]
    v_pk_mul_f32 v[18:19], v[18:19], v[46:47]
    v_pk_mul_f32 v[20:21], v[20:21], v[48:49]
    v_pk_mul_f32 v[22:23], v[22:23], v[48:49]
    v_pk_mul_f32 v[24:25], v[24:25], v[50:51]
    v_pk_mul_f32 v[26:27], v[26:27], v[50:51]
    v_pk_mul_f32 v[28:29], v[28:29], v[52:53]
    v_pk_mul_f32 v[30:31], v[30:31], v[52:53]
    v_pk_mul_f32 v[32:33], v[32:33], v[54:55]
    v_pk_mul_f32 v[34:35], v[34:35], v[54:55]
    s_waitcnt lgkmcnt(0)
    v_pk_mul_f32 v[4:5], v[4:5], v[40:41]
    v_pk_mul_f32 v[6:7], v[6:7], v[40:41]
    v_pk_add_f32 v[28:29], v[28:29], v[32:33]
    v_pk_add_f32 v[30:31], v[30:31], v[34:35]
    v_pk_add_f32 v[20:21], v[20:21], v[24:25]
    v_pk_add_f32 v[22:23], v[22:23], v[26:27]
    v_pk_add_f32 v[12:13], v[12:13], v[16:17]
    v_pk_add_f32 v[14:15], v[14:15], v[18:19]
    v_pk_add_f32 v[4:5], v[4:5], v[8:9]
    v_pk_add_f32 v[6:7], v[6:7], v[10:11]
    v_pk_add_f32 v[20:21], v[20:21], v[28:29]
    v_pk_add_f32 v[22:23], v[22:23], v[30:31]
    v_pk_add_f32 v[4:5], v[4:5], v[12:13]
    v_pk_add_f32 v[6:7], v[6:7], v[14:15]
    v_pk_add_f32 v[4:5], v[4:5], v[20:21]
    v_pk_add_f32 v[6:7], v[6:7], v[22:23]
    v_pk_add_f32 v[4:5], v[4:5], v[36:37]
    v_pk_add_f32 v[6:7], v[6:7], v[38:39]
    v_cvt_pk_bf16_f32 v4, v4, v5
    v_cvt_pk_bf16_f32 v5, v6, v7
    buffer_store_dwordx2 v[4:5], v83, s[56:59], 0 offen sc1
L_last:
    s_endpgm
.section .rodata,"a"
.p2align 6
.amdhsa_kernel standalone__tree_speculative_verify_tree_attention_over_candidate_token_tree__decode_kernel
  .amdhsa_next_free_vgpr 177
  .amdhsa_next_free_sgpr 64
  .amdhsa_accum_offset 180
  .amdhsa_group_segment_fixed_size 0
  .amdhsa_kernarg_size 72
  .amdhsa_user_sgpr_count 2
  .amdhsa_user_sgpr_kernarg_segment_ptr 1
  .amdhsa_system_sgpr_workgroup_id_x 1
  .amdhsa_float_denorm_mode_32 3
.end_amdhsa_kernel
```
